```python
import torch

def _softmax(x, axis=-1):
    return torch.softmax(x, dim=axis)

def _gelu(x):
    return torch.nn.functional.gelu(x, approximate='tanh')

def _silu(x):
    return torch.nn.functional.silu(x)

def _sigmoid(x):
    return torch.sigmoid(x)

def _layernorm(x, axis=-1, eps=1e-05):
    m = x.mean(dim=axis, keepdim=True)
    v = x.var(dim=axis, keepdim=True, unbiased=False)
    return (x - m) / torch.sqrt(v + eps)

def _scatter_add(tgt, idx, src, axis=0):
    return tgt.clone().index_add_(axis, idx, src)

def _segment_sum(src, seg, n):
    out = torch.zeros((n,) + src.shape[1:], dtype=src.dtype)
    return out.index_add_(0, seg, src)

def _pad(x, pw):
    flat = tuple((v for pair in reversed(pw) for v in pair))
    return torch.nn.functional.pad(x, flat)
kernel_name = 'standalone__molecular_angular_painn__graph'

def setup_inputs():

    _w = lambda a: (lambda t: t.to(torch.bfloat16) if t.is_floating_point() else t)(torch.as_tensor(a))
    N, deg, D = (10000, 16, 256)
    n_rbf = max(16, 4)
    E = N * deg
    cutoff = 5.0
    freqs = (torch.arange(1, n_rbf + 1) * torch.pi / cutoff).to(float)
    return {'sv': _w((lambda *s: torch.randn(*s, dtype=torch.bfloat16) * 0.4)(N, 4, D) * 0.3), 'pos': _w((lambda *s: torch.randn(*s, dtype=torch.bfloat16) * 1.6)(N, 3) * 1.2), 'src': _w((lambda lo, hi, *s: torch.randint(lo, hi, s))(0, N, E).to(torch.int64)), 'dst': _w((lambda lo, hi, *s: torch.randint(lo, hi, s))(0, N, E).to(torch.int64)), 'freqs': _w(freqs), 'w_phi1': _w((lambda *s: torch.randn(*s, dtype=torch.bfloat16) * 3.2)(D, D) / D ** 0.5), 'w_phi2': _w((lambda *s: torch.randn(*s, dtype=torch.bfloat16) * 1.6)(D, 3 * D) / D ** 0.5), 'w_rbf': _w((lambda *s: torch.randn(*s, dtype=torch.bfloat16) * 1.6)(n_rbf, 3 * D) / n_rbf ** 0.5)}

def reference(sv, pos, src, dst, freqs, w_phi1, w_phi2, w_rbf):
    N, _, D = sv.shape
    E = src.shape[0]
    PI, cutoff = (3.141592653589793, 5.0)
    s, v = (sv[:, 0, :].clone(), sv[:, 1:, :].clone())
    r_vec = pos[src] - pos[dst]
    d = torch.sqrt((r_vec * r_vec).sum(-1) + 1e-08)
    r_hat = r_vec / d[:, None]
    rbf = torch.sin(d[:, None] * freqs[None, :]) / d[:, None]
    fcut = 0.5 * (torch.cos(PI * d / cutoff) + 1.0)
    fcut = torch.where(d < cutoff, fcut, 0.0 * d)
    Wf = rbf @ w_rbf * fcut[:, None]
    phi = (_silu(s @ w_phi1) @ w_phi2)[src]
    m = phi * Wf
    m_s, m_vv, m_vr = (m[:, :D].clone(), m[:, D:2 * D].clone(), m[:, 2 * D:].clone())
    ds = _segment_sum(m_s, dst, N)
    dv_e = m_vv[:, None, :] * v[src] + m_vr[:, None, :] * r_hat[:, :, None]
    dv = _segment_sum(dv_e.reshape(E, 3 * D), dst, N).reshape(N, 3, D)
    return sv + torch.concatenate([ds[:, None, :], dv], axis=1)
```

```asm
; @launch grid=(256,1,1) block=(1024,1,1) lds=163840
.amdgcn_target "amdgcn-amd-amdhsa--gfx950"
.text
.globl standalone__molecular_angular_painn__graph_kernel
.p2align 8
.type standalone__molecular_angular_painn__graph_kernel,@function
standalone__molecular_angular_painn__graph_kernel:
    s_cmp_ge_u32 s2, 256
    s_cbranch_scc1 K2_END
    s_load_dwordx16 s[4:19], s[0:1], 0
    s_load_dwordx4 s[20:23], s[0:1], 72
    v_lshrrev_b32 v1, 6, v0
    v_and_b32 v2, 63, v0
    v_readfirstlane_b32 s3, v1
    s_mov_b32 s81, 0
    s_cmp_lt_u32 s3, 12
    s_cbranch_scc1 K1_NCT
    s_cmp_lt_u32 s2, 209
    s_cbranch_scc1 K1_NCT
    s_getpc_b64 s[60:61]
K1_PC:
    s_sub_u32 s60, s60, K1_PC-standalone__molecular_angular_painn__graph_kernel
    s_subb_u32 s61, s61, 0
    v_lshlrev_b32 v6, 7, v0
    v_subrev_u32 v6, 98304, v6
    v_min_u32 v6, K2_END-standalone__molecular_angular_painn__graph_kernel, v6
    global_load_dword v7, v6, s[60:61]
K1_NCT:
    s_cmp_ge_u32 s2, 209
    s_cbranch_scc1 K1_EDGE
    s_mul_i32 s40, s2, 48
    s_cmp_lt_u32 s3, 8
    s_cbranch_scc1 K1_COMP
K1_LOAD:
    s_cmp_ge_u32 s3, 12
    s_cbranch_scc1 K1_IDLE
    s_setprio 3
    s_sub_u32 s44, s3, 8
    s_mul_i32 s45, s44, 12
    v_lshrrev_b32 v3, 5, v2
    v_and_b32 v4, 31, v2
    v_add_u32 v7, s45, v3
    v_add_u32 v5, 0, v7
    v_and_b32 v6, 15, v5
    v_xor_b32 v6, v6, v4
    v_lshlrev_b32 v6, 4, v6
    v_lshl_add_u32 v8, v5, 11, v6
    v_add_u32 v5, 2, v7
    v_and_b32 v6, 15, v5
    v_xor_b32 v6, v6, v4
    v_lshlrev_b32 v6, 4, v6
    v_lshl_add_u32 v9, v5, 11, v6
    v_add_u32 v5, 4, v7
    v_and_b32 v6, 15, v5
    v_xor_b32 v6, v6, v4
    v_lshlrev_b32 v6, 4, v6
    v_lshl_add_u32 v10, v5, 11, v6
    v_add_u32 v5, 6, v7
    v_and_b32 v6, 15, v5
    v_xor_b32 v6, v6, v4
    v_lshlrev_b32 v6, 4, v6
    v_lshl_add_u32 v11, v5, 11, v6
    v_add_u32 v5, 8, v7
    v_and_b32 v6, 15, v5
    v_xor_b32 v6, v6, v4
    v_lshlrev_b32 v6, 4, v6
    v_lshl_add_u32 v12, v5, 11, v6
    v_add_u32 v5, 10, v7
    v_and_b32 v6, 15, v5
    v_xor_b32 v6, v6, v4
    v_lshlrev_b32 v6, 4, v6
    v_lshl_add_u32 v13, v5, 11, v6
    s_lshl_b32 s46, s40, 11
    s_lshl_b32 s45, s45, 9
    s_lshl_b32 s52, s44, 2
    s_and_b32 s52, s52, 4
    v_lshlrev_b32 v5, 2, v3
    v_xor_b32 v4, v5, v4
    v_lshlrev_b32 v4, 4, v4
    s_lshl_b32 s49, s44, 3
    v_add_u32 v3, s49, v3
    v_lshl_add_u32 v0, v3, 9, v4
    v_xor_b32 v14, 128, v0
    s_lshl_b32 s50, s44, 12
    s_lshr_b32 s47, s2, 3
    s_lshl_b32 s47, s47, 2
    s_add_u32 s47, s47, s44
    s_lshl_b32 s47, s47, 12
    v_lshlrev_b32 v5, 6, v2
    s_waitcnt lgkmcnt(0)
    s_mov_b32 s24, s4
    s_mov_b32 s25, s5
    s_mov_b32 s26, 0x1388000
    s_mov_b32 s27, 0x20000
    s_add_u32 m0, s45, 24576
    s_mov_b32 s28, s14
    s_mov_b32 s29, s15
    s_mov_b32 s30, 0x20000
    s_mov_b32 s31, 0x20000
    buffer_load_dwordx4 v8, s[24:27], s46 offen lds
    s_add_u32 m0, s45, 25600
    s_nop 0
    buffer_load_dwordx4 v9, s[24:27], s46 offen lds
    s_add_u32 m0, s45, 26624
    s_nop 0
    buffer_load_dwordx4 v10, s[24:27], s46 offen lds
    s_add_u32 m0, s45, 27648
    s_nop 0
    buffer_load_dwordx4 v11, s[24:27], s46 offen lds
    s_add_u32 m0, s45, 28672
    s_nop 0
    buffer_load_dwordx4 v12, s[24:27], s46 offen lds
    s_add_u32 m0, s45, 29696
    s_nop 0
    buffer_load_dwordx4 v13, s[24:27], s46 offen lds
    s_add_u32 m0, s50, 49152
    s_mov_b32 s43, 0
    buffer_load_dwordx4 v0, s[28:31], s43 offen offset:0 lds
    buffer_load_dwordx4 v14, s[28:31], s43 offen offset:1024 lds
    buffer_load_dwordx4 v0, s[28:31], s43 offen offset:2048 lds
    buffer_load_dwordx4 v14, s[28:31], s43 offen offset:3072 lds
    s_add_u32 m0, s50, 65536
    s_mov_b32 s43, 16384
    buffer_load_dwordx4 v0, s[28:31], s43 offen offset:0 lds
    buffer_load_dwordx4 v14, s[28:31], s43 offen offset:1024 lds
    buffer_load_dwordx4 v0, s[28:31], s43 offen offset:2048 lds
    buffer_load_dwordx4 v14, s[28:31], s43 offen offset:3072 lds
    s_mov_b32 s32, s16
    s_mov_b32 s33, s17
    s_mov_b32 s34, 0x60000
    s_mov_b32 s35, 0x20000
    buffer_load_dword v6, v5, s[32:35], s47 offen
    s_add_u32 m0, s50, 81920
    s_mov_b32 s43, 32768
    buffer_load_dwordx4 v0, s[28:31], s43 offen offset:0 lds
    buffer_load_dwordx4 v14, s[28:31], s43 offen offset:1024 lds
    buffer_load_dwordx4 v0, s[28:31], s43 offen offset:2048 lds
    buffer_load_dwordx4 v14, s[28:31], s43 offen offset:3072 lds
    s_add_u32 m0, s50, 98304
    s_mov_b32 s43, 49152
    buffer_load_dwordx4 v0, s[28:31], s43 offen offset:0 lds
    buffer_load_dwordx4 v14, s[28:31], s43 offen offset:1024 lds
    buffer_load_dwordx4 v0, s[28:31], s43 offen offset:2048 lds
    buffer_load_dwordx4 v14, s[28:31], s43 offen offset:3072 lds
    v_mul_u32_u24 v3, 1536, v3
    v_add_u32 v1, v3, v4
    v_xor_b32 v15, 128, v1
    s_waitcnt vmcnt(9)
    s_barrier
    s_add_u32 m0, s50, 114688
    s_mov_b32 s43, 65536
    buffer_load_dwordx4 v0, s[28:31], s43 offen offset:0 lds
    buffer_load_dwordx4 v14, s[28:31], s43 offen offset:1024 lds
    buffer_load_dwordx4 v0, s[28:31], s43 offen offset:2048 lds
    buffer_load_dwordx4 v14, s[28:31], s43 offen offset:3072 lds
    s_add_u32 m0, s50, 131072
    s_mov_b32 s43, 81920
    buffer_load_dwordx4 v0, s[28:31], s43 offen offset:0 lds
    buffer_load_dwordx4 v14, s[28:31], s43 offen offset:1024 lds
    buffer_load_dwordx4 v0, s[28:31], s43 offen offset:2048 lds
    buffer_load_dwordx4 v14, s[28:31], s43 offen offset:3072 lds
    s_add_u32 m0, s50, 147456
    s_mov_b32 s43, 98304
    buffer_load_dwordx4 v0, s[28:31], s43 offen offset:0 lds
    buffer_load_dwordx4 v14, s[28:31], s43 offen offset:1024 lds
    buffer_load_dwordx4 v0, s[28:31], s43 offen offset:2048 lds
    buffer_load_dwordx4 v14, s[28:31], s43 offen offset:3072 lds
    s_add_u32 m0, s50, 0
    s_mov_b32 s43, 114688
    buffer_load_dwordx4 v0, s[28:31], s43 offen offset:0 lds
    buffer_load_dwordx4 v14, s[28:31], s43 offen offset:1024 lds
    buffer_load_dwordx4 v0, s[28:31], s43 offen offset:2048 lds
    buffer_load_dwordx4 v14, s[28:31], s43 offen offset:3072 lds
    s_waitcnt vmcnt(16)
    s_barrier
    s_add_u32 m0, s50, 49152
    s_mov_b32 s43, 0
    buffer_load_dwordx4 v1, s[32:35], s43 offen offset:0 lds
    s_mov_b32 s43, 2048
    buffer_load_dwordx4 v15, s[32:35], s43 offen offset:1024 lds
    s_mov_b32 s43, 4096
    buffer_load_dwordx4 v1, s[32:35], s43 offen offset:2048 lds
    s_mov_b32 s43, 6144
    buffer_load_dwordx4 v15, s[32:35], s43 offen offset:3072 lds
    s_add_u32 m0, s50, 65536
    s_mov_b32 s43, 512
    buffer_load_dwordx4 v1, s[32:35], s43 offen offset:0 lds
    s_mov_b32 s43, 2560
    buffer_load_dwordx4 v15, s[32:35], s43 offen offset:1024 lds
    s_mov_b32 s43, 4608
    buffer_load_dwordx4 v1, s[32:35], s43 offen offset:2048 lds
    s_mov_b32 s43, 6656
    buffer_load_dwordx4 v15, s[32:35], s43 offen offset:3072 lds
    s_waitcnt vmcnt(16)
    s_barrier
    s_add_u32 m0, s50, 81920
    s_mov_b32 s43, 1024
    buffer_load_dwordx4 v1, s[32:35], s43 offen offset:0 lds
    s_mov_b32 s43, 3072
    buffer_load_dwordx4 v15, s[32:35], s43 offen offset:1024 lds
    s_mov_b32 s43, 5120
    buffer_load_dwordx4 v1, s[32:35], s43 offen offset:2048 lds
    s_mov_b32 s43, 7168
    buffer_load_dwordx4 v15, s[32:35], s43 offen offset:3072 lds
    s_add_u32 m0, s50, 98304
    s_mov_b32 s43, 49152
    buffer_load_dwordx4 v1, s[32:35], s43 offen offset:0 lds
    s_mov_b32 s43, 51200
    buffer_load_dwordx4 v15, s[32:35], s43 offen offset:1024 lds
    s_mov_b32 s43, 53248
    buffer_load_dwordx4 v1, s[32:35], s43 offen offset:2048 lds
    s_mov_b32 s43, 55296
    buffer_load_dwordx4 v15, s[32:35], s43 offen offset:3072 lds
    s_waitcnt vmcnt(16)
    s_barrier
    s_add_u32 m0, s50, 114688
    s_mov_b32 s43, 49664
    buffer_load_dwordx4 v1, s[32:35], s43 offen offset:0 lds
    s_mov_b32 s43, 51712
    buffer_load_dwordx4 v15, s[32:35], s43 offen offset:1024 lds
    s_mov_b32 s43, 53760
    buffer_load_dwordx4 v1, s[32:35], s43 offen offset:2048 lds
    s_mov_b32 s43, 55808
    buffer_load_dwordx4 v15, s[32:35], s43 offen offset:3072 lds
    s_add_u32 m0, s50, 131072
    s_mov_b32 s43, 50176
    buffer_load_dwordx4 v1, s[32:35], s43 offen offset:0 lds
    s_mov_b32 s43, 52224
    buffer_load_dwordx4 v15, s[32:35], s43 offen offset:1024 lds
    s_mov_b32 s43, 54272
    buffer_load_dwordx4 v1, s[32:35], s43 offen offset:2048 lds
    s_mov_b32 s43, 56320
    buffer_load_dwordx4 v15, s[32:35], s43 offen offset:3072 lds
    s_waitcnt vmcnt(16)
    s_barrier
    s_add_u32 m0, s50, 147456
    s_mov_b32 s43, 98304
    buffer_load_dwordx4 v1, s[32:35], s43 offen offset:0 lds
    s_mov_b32 s43, 100352
    buffer_load_dwordx4 v15, s[32:35], s43 offen offset:1024 lds
    s_mov_b32 s43, 102400
    buffer_load_dwordx4 v1, s[32:35], s43 offen offset:2048 lds
    s_mov_b32 s43, 104448
    buffer_load_dwordx4 v15, s[32:35], s43 offen offset:3072 lds
    v_and_b32 v3, 15, v2
    v_cmp_le_u32 vcc, 4, v3
    v_lshlrev_b32 v3, 7, v2
    v_mov_b32 v4, 0x80000000
    v_cndmask_b32 v3, v4, v3, vcc
    s_lshl_b32 s48, s44, 13
    s_add_u32 s48, s48, s46
    s_and_b32 s49, s2, 7
    s_cselect_b32 s51, 8, 6
    s_cselect_b32 s53, 0, 2
    s_cmp_eq_u32 s2, 208
    s_cselect_b32 s51, 0, s51
    s_lshl_b32 s51, s51, 13
    s_add_u32 s49, s48, s51
    buffer_load_dword v7, v3, s[24:27], s49 offen
    s_add_u32 s49, s49, 32768
    s_cmp_lt_u32 s44, s53
    s_cselect_b32 s49, s49, 0x40000000
    buffer_load_dword v7, v3, s[24:27], s49 offen
    s_barrier
    s_add_u32 m0, s50, 49152
    s_mov_b32 s43, 98816
    buffer_load_dwordx4 v1, s[32:35], s43 offen offset:0 lds
    s_mov_b32 s43, 100864
    buffer_load_dwordx4 v15, s[32:35], s43 offen offset:1024 lds
    s_mov_b32 s43, 102912
    buffer_load_dwordx4 v1, s[32:35], s43 offen offset:2048 lds
    s_mov_b32 s43, 104960
    buffer_load_dwordx4 v15, s[32:35], s43 offen offset:3072 lds
    s_waitcnt vmcnt(18)
    s_barrier
    s_add_u32 m0, s50, 65536
    s_mov_b32 s43, 99328
    buffer_load_dwordx4 v1, s[32:35], s43 offen offset:0 lds
    s_mov_b32 s43, 101376
    buffer_load_dwordx4 v15, s[32:35], s43 offen offset:1024 lds
    s_mov_b32 s43, 103424
    buffer_load_dwordx4 v1, s[32:35], s43 offen offset:2048 lds
    s_mov_b32 s43, 105472
    buffer_load_dwordx4 v15, s[32:35], s43 offen offset:3072 lds
    s_waitcnt vmcnt(14)
    s_barrier
    s_add_u32 m0, s50, 81920
    s_mov_b32 s43, 147456
    buffer_load_dwordx4 v1, s[32:35], s43 offen offset:0 lds
    s_mov_b32 s43, 149504
    buffer_load_dwordx4 v15, s[32:35], s43 offen offset:1024 lds
    s_mov_b32 s43, 151552
    buffer_load_dwordx4 v1, s[32:35], s43 offen offset:2048 lds
    s_mov_b32 s43, 153600
    buffer_load_dwordx4 v15, s[32:35], s43 offen offset:3072 lds
    s_add_u32 m0, s50, 98304
    s_mov_b32 s43, 147968
    buffer_load_dwordx4 v1, s[32:35], s43 offen offset:0 lds
    s_mov_b32 s43, 150016
    buffer_load_dwordx4 v15, s[32:35], s43 offen offset:1024 lds
    s_mov_b32 s43, 152064
    buffer_load_dwordx4 v1, s[32:35], s43 offen offset:2048 lds
    s_mov_b32 s43, 154112
    buffer_load_dwordx4 v15, s[32:35], s43 offen offset:3072 lds
    s_waitcnt vmcnt(12)
    s_barrier
    s_add_u32 m0, s50, 114688
    s_mov_b32 s43, 148480
    buffer_load_dwordx4 v1, s[32:35], s43 offen offset:0 lds
    s_mov_b32 s43, 150528
    buffer_load_dwordx4 v15, s[32:35], s43 offen offset:1024 lds
    s_mov_b32 s43, 152576
    buffer_load_dwordx4 v1, s[32:35], s43 offen offset:2048 lds
    s_mov_b32 s43, 154624
    buffer_load_dwordx4 v15, s[32:35], s43 offen offset:3072 lds
    s_add_u32 m0, s50, 131072
    s_mov_b32 s43, 196608
    buffer_load_dwordx4 v1, s[32:35], s43 offen offset:0 lds
    s_mov_b32 s43, 198656
    buffer_load_dwordx4 v15, s[32:35], s43 offen offset:1024 lds
    s_mov_b32 s43, 200704
    buffer_load_dwordx4 v1, s[32:35], s43 offen offset:2048 lds
    s_mov_b32 s43, 202752
    buffer_load_dwordx4 v15, s[32:35], s43 offen offset:3072 lds
    s_waitcnt vmcnt(12)
    s_barrier
    s_add_u32 m0, s50, 147456
    s_mov_b32 s43, 197120
    buffer_load_dwordx4 v1, s[32:35], s43 offen offset:0 lds
    s_mov_b32 s43, 199168
    buffer_load_dwordx4 v15, s[32:35], s43 offen offset:1024 lds
    s_mov_b32 s43, 201216
    buffer_load_dwordx4 v1, s[32:35], s43 offen offset:2048 lds
    s_mov_b32 s43, 203264
    buffer_load_dwordx4 v15, s[32:35], s43 offen offset:3072 lds
    s_add_u32 m0, s50, 49152
    s_mov_b32 s43, 197632
    buffer_load_dwordx4 v1, s[32:35], s43 offen offset:0 lds
    s_mov_b32 s43, 199680
    buffer_load_dwordx4 v15, s[32:35], s43 offen offset:1024 lds
    s_mov_b32 s43, 201728
    buffer_load_dwordx4 v1, s[32:35], s43 offen offset:2048 lds
    s_mov_b32 s43, 203776
    buffer_load_dwordx4 v15, s[32:35], s43 offen offset:3072 lds
    s_waitcnt vmcnt(12)
    s_barrier
    s_add_u32 m0, s50, 65536
    s_mov_b32 s43, 245760
    buffer_load_dwordx4 v1, s[32:35], s43 offen offset:0 lds
    s_mov_b32 s43, 247808
    buffer_load_dwordx4 v15, s[32:35], s43 offen offset:1024 lds
    s_mov_b32 s43, 249856
    buffer_load_dwordx4 v1, s[32:35], s43 offen offset:2048 lds
    s_mov_b32 s43, 251904
    buffer_load_dwordx4 v15, s[32:35], s43 offen offset:3072 lds
    s_add_u32 m0, s50, 81920
    s_mov_b32 s43, 246272
    buffer_load_dwordx4 v1, s[32:35], s43 offen offset:0 lds
    s_mov_b32 s43, 248320
    buffer_load_dwordx4 v15, s[32:35], s43 offen offset:1024 lds
    s_mov_b32 s43, 250368
    buffer_load_dwordx4 v1, s[32:35], s43 offen offset:2048 lds
    s_mov_b32 s43, 252416
    buffer_load_dwordx4 v15, s[32:35], s43 offen offset:3072 lds
    s_waitcnt vmcnt(12)
    s_barrier
    s_add_u32 m0, s50, 98304
    s_mov_b32 s43, 246784
    buffer_load_dwordx4 v1, s[32:35], s43 offen offset:0 lds
    s_mov_b32 s43, 248832
    buffer_load_dwordx4 v15, s[32:35], s43 offen offset:1024 lds
    s_mov_b32 s43, 250880
    buffer_load_dwordx4 v1, s[32:35], s43 offen offset:2048 lds
    s_mov_b32 s43, 252928
    buffer_load_dwordx4 v15, s[32:35], s43 offen offset:3072 lds
    s_add_u32 m0, s50, 114688
    s_mov_b32 s43, 294912
    buffer_load_dwordx4 v1, s[32:35], s43 offen offset:0 lds
    s_mov_b32 s43, 296960
    buffer_load_dwordx4 v15, s[32:35], s43 offen offset:1024 lds
    s_mov_b32 s43, 299008
    buffer_load_dwordx4 v1, s[32:35], s43 offen offset:2048 lds
    s_mov_b32 s43, 301056
    buffer_load_dwordx4 v15, s[32:35], s43 offen offset:3072 lds
    s_waitcnt vmcnt(12)
    s_barrier
    s_add_u32 m0, s50, 131072
    s_mov_b32 s43, 295424
    buffer_load_dwordx4 v1, s[32:35], s43 offen offset:0 lds
    s_mov_b32 s43, 297472
    buffer_load_dwordx4 v15, s[32:35], s43 offen offset:1024 lds
    s_mov_b32 s43, 299520
    buffer_load_dwordx4 v1, s[32:35], s43 offen offset:2048 lds
    s_mov_b32 s43, 301568
    buffer_load_dwordx4 v15, s[32:35], s43 offen offset:3072 lds
    s_add_u32 m0, s50, 147456
    s_mov_b32 s43, 295936
    buffer_load_dwordx4 v1, s[32:35], s43 offen offset:0 lds
    s_mov_b32 s43, 297984
    buffer_load_dwordx4 v15, s[32:35], s43 offen offset:1024 lds
    s_mov_b32 s43, 300032
    buffer_load_dwordx4 v1, s[32:35], s43 offen offset:2048 lds
    s_mov_b32 s43, 302080
    buffer_load_dwordx4 v15, s[32:35], s43 offen offset:3072 lds
    s_waitcnt vmcnt(12)
    s_barrier
    s_add_u32 m0, s50, 49152
    s_mov_b32 s43, 344064
    buffer_load_dwordx4 v1, s[32:35], s43 offen offset:0 lds
    s_mov_b32 s43, 346112
    buffer_load_dwordx4 v15, s[32:35], s43 offen offset:1024 lds
    s_mov_b32 s43, 348160
    buffer_load_dwordx4 v1, s[32:35], s43 offen offset:2048 lds
    s_mov_b32 s43, 350208
    buffer_load_dwordx4 v15, s[32:35], s43 offen offset:3072 lds
    s_add_u32 m0, s50, 65536
    s_mov_b32 s43, 344576
    buffer_load_dwordx4 v1, s[32:35], s43 offen offset:0 lds
    s_mov_b32 s43, 346624
    buffer_load_dwordx4 v15, s[32:35], s43 offen offset:1024 lds
    s_mov_b32 s43, 348672
    buffer_load_dwordx4 v1, s[32:35], s43 offen offset:2048 lds
    s_mov_b32 s43, 350720
    buffer_load_dwordx4 v15, s[32:35], s43 offen offset:3072 lds
    s_waitcnt vmcnt(12)
    s_barrier
    s_add_u32 m0, s50, 81920
    s_mov_b32 s43, 345088
    buffer_load_dwordx4 v1, s[32:35], s43 offen offset:0 lds
    s_mov_b32 s43, 347136
    buffer_load_dwordx4 v15, s[32:35], s43 offen offset:1024 lds
    s_mov_b32 s43, 349184
    buffer_load_dwordx4 v1, s[32:35], s43 offen offset:2048 lds
    s_mov_b32 s43, 351232
    buffer_load_dwordx4 v15, s[32:35], s43 offen offset:3072 lds
    s_add_u32 s48, s46, 512
    s_add_u32 m0, s45, 24576
    s_nop 0
    buffer_load_dwordx4 v8, s[24:27], s48 offen lds
    s_add_u32 m0, s45, 25600
    s_nop 0
    buffer_load_dwordx4 v9, s[24:27], s48 offen lds
    s_add_u32 m0, s45, 26624
    s_nop 0
    buffer_load_dwordx4 v10, s[24:27], s48 offen lds
    s_add_u32 m0, s45, 27648
    s_nop 0
    buffer_load_dwordx4 v11, s[24:27], s48 offen lds
    s_add_u32 m0, s45, 28672
    s_nop 0
    buffer_load_dwordx4 v12, s[24:27], s48 offen lds
    s_add_u32 m0, s45, 29696
    s_nop 0
    buffer_load_dwordx4 v13, s[24:27], s48 offen lds
    s_waitcnt vmcnt(6)
    s_barrier
    s_add_u32 s48, s46, 1024
    s_add_u32 m0, s45, 98304
    s_nop 0
    buffer_load_dwordx4 v8, s[24:27], s48 offen lds
    s_add_u32 m0, s45, 99328
    s_nop 0
    buffer_load_dwordx4 v9, s[24:27], s48 offen lds
    s_add_u32 m0, s45, 100352
    s_nop 0
    buffer_load_dwordx4 v10, s[24:27], s48 offen lds
    s_add_u32 m0, s45, 101376
    s_nop 0
    buffer_load_dwordx4 v11, s[24:27], s48 offen lds
    s_add_u32 m0, s45, 102400
    s_nop 0
    buffer_load_dwordx4 v12, s[24:27], s48 offen lds
    s_add_u32 m0, s45, 103424
    s_nop 0
    buffer_load_dwordx4 v13, s[24:27], s48 offen lds
    s_add_u32 s48, s46, 1536
    s_add_u32 m0, s45, 122880
    s_nop 0
    buffer_load_dwordx4 v8, s[24:27], s48 offen lds
    s_add_u32 m0, s45, 123904
    s_nop 0
    buffer_load_dwordx4 v9, s[24:27], s48 offen lds
    s_add_u32 m0, s45, 124928
    s_nop 0
    buffer_load_dwordx4 v10, s[24:27], s48 offen lds
    s_add_u32 m0, s45, 125952
    s_nop 0
    buffer_load_dwordx4 v11, s[24:27], s48 offen lds
    s_add_u32 m0, s45, 126976
    s_nop 0
    buffer_load_dwordx4 v12, s[24:27], s48 offen lds
    s_add_u32 m0, s45, 128000
    s_nop 0
    buffer_load_dwordx4 v13, s[24:27], s48 offen lds
    v_lshrrev_b32 v3, 5, v2
    v_lshlrev_b32 v3, 17, v3
    v_bfe_u32 v4, v2, 3, 2
    v_lshl_add_u32 v3, v4, 9, v3
    v_and_b32 v4, 7, v2
    v_lshl_add_u32 v3, v4, 4, v3
    s_lshr_b32 s51, s2, 3
    s_lshl_b32 s51, s51, 12
    s_and_b32 s53, s2, 1
    s_lshl_b32 s53, s53, 11
    s_add_u32 s51, s51, s53
    s_bfe_u32 s53, s2, 0x20001
    s_lshl_b32 s53, s53, 7
    s_add_u32 s51, s51, s53
    s_lshl_b32 s53, s44, 18
    s_add_u32 s51, s51, s53
    s_lshl_b32 s53, s44, 10
    s_add_u32 s53, s53, 80896
    v_lshlrev_b32 v4, 4, v2
    v_add_u32 v4, s53, v4
    buffer_load_dwordx4 v[48:51], v3, s[24:27], s51 offen
    s_add_u32 s51, s51, 0x100000
    buffer_load_dwordx4 v[52:55], v3, s[24:27], s51 offen
    s_add_u32 s51, s51, 0x100000
    buffer_load_dwordx4 v[56:59], v3, s[24:27], s51 offen
    s_add_u32 s51, s51, 0x100000
    buffer_load_dwordx4 v[60:63], v3, s[24:27], s51 offen
    s_add_u32 s51, s51, 0x100000
    buffer_load_dwordx4 v[64:67], v3, s[24:27], s51 offen
    s_add_u32 s51, s51, 0x100000
    buffer_load_dwordx4 v[68:71], v3, s[24:27], s51 offen
    s_add_u32 s51, s51, 0x100000
    s_waitcnt vmcnt(6)
    s_barrier
    s_setprio 0
    s_barrier
    s_waitcnt vmcnt(5)
    ds_write_b128 v4, v[48:51] offset:0
    s_waitcnt vmcnt(4)
    ds_write_b128 v4, v[52:55] offset:4096
    s_waitcnt vmcnt(3)
    ds_write_b128 v4, v[56:59] offset:8192
    s_waitcnt vmcnt(2)
    ds_write_b128 v4, v[60:63] offset:12288
    s_waitcnt vmcnt(1)
    ds_write_b128 v4, v[64:67] offset:16384
    s_waitcnt vmcnt(0)
    ds_write_b128 v4, v[68:71] offset:20480
    s_branch K2_START
K1_COMP:
    s_lshl_b32 s44, s3, 2
    v_and_b32 v10, 15, v2
    v_lshrrev_b32 v11, 4, v2
    v_xor_b32 v13, v10, v11
    v_lshlrev_b32 v14, 9, v10
    v_xor_b32 v16, 0, v13
    v_lshl_add_u32 v2, v16, 4, v14
    v_xor_b32 v16, 4, v13
    v_lshl_add_u32 v3, v16, 4, v14
    v_xor_b32 v16, 8, v13
    v_lshl_add_u32 v4, v16, 4, v14
    v_xor_b32 v16, 12, v13
    v_lshl_add_u32 v5, v16, 4, v14
    v_lshrrev_b32 v12, 2, v10
    v_lshlrev_b32 v14, 2, v11
    v_and_b32 v16, 4, v14
    v_or_b32 v16, v16, v12
    v_and_b32 v17, 3, v10
    v_add_u32 v17, s44, v17
    v_lshlrev_b32 v16, 2, v12
    v_xor_b32 v17, v17, v16
    v_lshlrev_b32 v17, 4, v17
    v_and_b32 v16, 1, v10
    v_lshl_add_u32 v12, v11, 3, v12
    v_lshl_add_u32 v124, v12, 9, v17
    v_cmp_eq_u32 vcc, 0, v16
    v_mov_b32 v17, 0x3020706
    v_mov_b32 v18, 0x5040100
    v_cndmask_b32 v127, v17, v18, vcc
    v_bfe_u32 v15, v10, 1, 1
    v_lshl_add_u32 v15, v16, 1, v15
    v_and_or_b32 v15, v10, 12, v15
    v_lshrrev_b32 v13, 2, v15
    v_add_u32 v13, s44, v13
    v_and_b32 v17, 3, v15
    v_lshlrev_b32 v17, 2, v17
    v_xor_b32 v13, v13, v14
    v_lshl_add_u32 v17, v11, 11, v17
    v_xor_b32 v16, 0, v13
    v_lshl_add_u32 v16, v16, 4, v17
    v_add_u32 v6, 0, v16
    v_xor_b32 v16, 1, v13
    v_lshl_add_u32 v16, v16, 4, v17
    v_add_u32 v7, 512, v16
    v_xor_b32 v16, 2, v13
    v_lshl_add_u32 v16, v16, 4, v17
    v_add_u32 v8, 1024, v16
    v_xor_b32 v16, 3, v13
    v_lshl_add_u32 v16, v16, 4, v17
    v_add_u32 v9, 1536, v16
    v_add_u32 v14, s40, v14
    v_lshlrev_b32 v16, 4, v15
    v_lshl_add_u32 v0, v14, 8, v16
    v_lshlrev_b32 v15, 2, v15
    v_lshl_add_u32 v1, v14, 7, v15
    s_mul_i32 s47, s3, 2572288
    s_lshr_b32 s48, s3, 1
    s_mul_i32 s48, s48, 1286144
    s_and_b32 s49, s3, 1
    s_lshl_b32 s49, s49, 6
    s_add_u32 s48, s48, s49
    s_add_u32 s48, s48, 20578304
    s_mov_b32 s50, 0x7060100
    s_mov_b32 s51, 0x7060302
    v_mov_b32 v11, 0xbfb8aa3b
    v_mov_b32 v10, 0xffff0000
    s_waitcnt lgkmcnt(0)
    s_mov_b32 s36, s22
    s_mov_b32 s37, s23
    s_mov_b32 s38, 0x10000000
    s_mov_b32 s39, 0x20000
    s_barrier
    v_add_u32 v125, 49152, v124
    v_xor_b32 v126, 8, v125
    ds_read_b64_tr_b16 v[36:37], v125 offset:0
    ds_read_b64_tr_b16 v[38:39], v125 offset:2048
    ds_read_b64_tr_b16 v[40:41], v126 offset:0
    ds_read_b64_tr_b16 v[42:43], v126 offset:2048
    ds_read_b128 v[12:15], v2 offset:24576
    ds_read_b128 v[16:19], v2 offset:32768
    ds_read_b128 v[20:23], v2 offset:40960
    s_waitcnt lgkmcnt(0)
    v_add_u32 v125, 65536, v124
    v_xor_b32 v126, 8, v125
    v_mfma_f32_16x16x32_bf16 v[100:103], v[12:15], v[36:39], 0
    ds_read_b64_tr_b16 v[44:45], v125 offset:0
    ds_read_b64_tr_b16 v[46:47], v125 offset:2048
    v_mfma_f32_16x16x32_bf16 v[104:107], v[12:15], v[40:43], 0
    ds_read_b64_tr_b16 v[48:49], v126 offset:0
    ds_read_b64_tr_b16 v[50:51], v126 offset:2048
    v_mfma_f32_16x16x32_bf16 v[108:111], v[16:19], v[36:39], 0
    ds_read_b128 v[24:27], v3 offset:24576
    ds_read_b128 v[28:31], v3 offset:32768
    v_mfma_f32_16x16x32_bf16 v[112:115], v[16:19], v[40:43], 0
    ds_read_b128 v[32:35], v3 offset:40960
    v_mfma_f32_16x16x32_bf16 v[116:119], v[20:23], v[36:39], 0
    v_mfma_f32_16x16x32_bf16 v[120:123], v[20:23], v[40:43], 0
    s_waitcnt lgkmcnt(0)
    s_barrier
    v_add_u32 v125, 81920, v124
    v_xor_b32 v126, 8, v125
    v_mfma_f32_16x16x32_bf16 v[100:103], v[24:27], v[44:47], v[100:103]
    ds_read_b64_tr_b16 v[36:37], v125 offset:0
    ds_read_b64_tr_b16 v[38:39], v125 offset:2048
    v_mfma_f32_16x16x32_bf16 v[104:107], v[24:27], v[48:51], v[104:107]
    ds_read_b64_tr_b16 v[40:41], v126 offset:0
    ds_read_b64_tr_b16 v[42:43], v126 offset:2048
    v_mfma_f32_16x16x32_bf16 v[108:111], v[28:31], v[44:47], v[108:111]
    ds_read_b128 v[12:15], v4 offset:24576
    ds_read_b128 v[16:19], v4 offset:32768
    v_mfma_f32_16x16x32_bf16 v[112:115], v[28:31], v[48:51], v[112:115]
    ds_read_b128 v[20:23], v4 offset:40960
    v_mfma_f32_16x16x32_bf16 v[116:119], v[32:35], v[44:47], v[116:119]
    v_mfma_f32_16x16x32_bf16 v[120:123], v[32:35], v[48:51], v[120:123]
    s_waitcnt lgkmcnt(0)
    v_add_u32 v125, 98304, v124
    v_xor_b32 v126, 8, v125
    v_mfma_f32_16x16x32_bf16 v[100:103], v[12:15], v[36:39], v[100:103]
    ds_read_b64_tr_b16 v[44:45], v125 offset:0
    ds_read_b64_tr_b16 v[46:47], v125 offset:2048
    v_mfma_f32_16x16x32_bf16 v[104:107], v[12:15], v[40:43], v[104:107]
    ds_read_b64_tr_b16 v[48:49], v126 offset:0
    ds_read_b64_tr_b16 v[50:51], v126 offset:2048
    v_mfma_f32_16x16x32_bf16 v[108:111], v[16:19], v[36:39], v[108:111]
    ds_read_b128 v[24:27], v5 offset:24576
    ds_read_b128 v[28:31], v5 offset:32768
    v_mfma_f32_16x16x32_bf16 v[112:115], v[16:19], v[40:43], v[112:115]
    ds_read_b128 v[32:35], v5 offset:40960
    v_mfma_f32_16x16x32_bf16 v[116:119], v[20:23], v[36:39], v[116:119]
    v_mfma_f32_16x16x32_bf16 v[120:123], v[20:23], v[40:43], v[120:123]
    s_waitcnt lgkmcnt(0)
    s_barrier
    v_add_u32 v125, 114688, v124
    v_xor_b32 v126, 8, v125
    v_mfma_f32_16x16x32_bf16 v[100:103], v[24:27], v[44:47], v[100:103]
    ds_read_b64_tr_b16 v[36:37], v125 offset:0
    ds_read_b64_tr_b16 v[38:39], v125 offset:2048
    v_mfma_f32_16x16x32_bf16 v[104:107], v[24:27], v[48:51], v[104:107]
    ds_read_b64_tr_b16 v[40:41], v126 offset:0
    ds_read_b64_tr_b16 v[42:43], v126 offset:2048
    v_mfma_f32_16x16x32_bf16 v[108:111], v[28:31], v[44:47], v[108:111]
    ds_read_b128 v[12:15], v2 offset:24832
    ds_read_b128 v[16:19], v2 offset:33024
    v_mfma_f32_16x16x32_bf16 v[112:115], v[28:31], v[48:51], v[112:115]
    ds_read_b128 v[20:23], v2 offset:41216
    v_mfma_f32_16x16x32_bf16 v[116:119], v[32:35], v[44:47], v[116:119]
    v_mfma_f32_16x16x32_bf16 v[120:123], v[32:35], v[48:51], v[120:123]
    s_waitcnt lgkmcnt(0)
    v_add_u32 v125, 131072, v124
    v_xor_b32 v126, 8, v125
    v_mfma_f32_16x16x32_bf16 v[100:103], v[12:15], v[36:39], v[100:103]
    ds_read_b64_tr_b16 v[44:45], v125 offset:0
    ds_read_b64_tr_b16 v[46:47], v125 offset:2048
    v_mfma_f32_16x16x32_bf16 v[104:107], v[12:15], v[40:43], v[104:107]
    ds_read_b64_tr_b16 v[48:49], v126 offset:0
    ds_read_b64_tr_b16 v[50:51], v126 offset:2048
    v_mfma_f32_16x16x32_bf16 v[108:111], v[16:19], v[36:39], v[108:111]
    ds_read_b128 v[24:27], v3 offset:24832
    ds_read_b128 v[28:31], v3 offset:33024
    v_mfma_f32_16x16x32_bf16 v[112:115], v[16:19], v[40:43], v[112:115]
    ds_read_b128 v[32:35], v3 offset:41216
    v_mfma_f32_16x16x32_bf16 v[116:119], v[20:23], v[36:39], v[116:119]
    v_mfma_f32_16x16x32_bf16 v[120:123], v[20:23], v[40:43], v[120:123]
    s_waitcnt lgkmcnt(0)
    s_barrier
    v_add_u32 v125, 147456, v124
    v_xor_b32 v126, 8, v125
    v_mfma_f32_16x16x32_bf16 v[100:103], v[24:27], v[44:47], v[100:103]
    ds_read_b64_tr_b16 v[36:37], v125 offset:0
    ds_read_b64_tr_b16 v[38:39], v125 offset:2048
    v_mfma_f32_16x16x32_bf16 v[104:107], v[24:27], v[48:51], v[104:107]
    ds_read_b64_tr_b16 v[40:41], v126 offset:0
    ds_read_b64_tr_b16 v[42:43], v126 offset:2048
    v_mfma_f32_16x16x32_bf16 v[108:111], v[28:31], v[44:47], v[108:111]
    ds_read_b128 v[12:15], v4 offset:24832
    ds_read_b128 v[16:19], v4 offset:33024
    v_mfma_f32_16x16x32_bf16 v[112:115], v[28:31], v[48:51], v[112:115]
    ds_read_b128 v[20:23], v4 offset:41216
    v_mfma_f32_16x16x32_bf16 v[116:119], v[32:35], v[44:47], v[116:119]
    v_mfma_f32_16x16x32_bf16 v[120:123], v[32:35], v[48:51], v[120:123]
    s_waitcnt lgkmcnt(0)
    v_add_u32 v125, 0, v124
    v_xor_b32 v126, 8, v125
    v_mfma_f32_16x16x32_bf16 v[100:103], v[12:15], v[36:39], v[100:103]
    ds_read_b64_tr_b16 v[44:45], v125 offset:0
    ds_read_b64_tr_b16 v[46:47], v125 offset:2048
    v_mfma_f32_16x16x32_bf16 v[104:107], v[12:15], v[40:43], v[104:107]
    ds_read_b64_tr_b16 v[48:49], v126 offset:0
    ds_read_b64_tr_b16 v[50:51], v126 offset:2048
    v_mfma_f32_16x16x32_bf16 v[108:111], v[16:19], v[36:39], v[108:111]
    ds_read_b128 v[24:27], v5 offset:24832
    ds_read_b128 v[28:31], v5 offset:33024
    v_mfma_f32_16x16x32_bf16 v[112:115], v[16:19], v[40:43], v[112:115]
    ds_read_b128 v[32:35], v5 offset:41216
    v_mfma_f32_16x16x32_bf16 v[116:119], v[20:23], v[36:39], v[116:119]
    v_mfma_f32_16x16x32_bf16 v[120:123], v[20:23], v[40:43], v[120:123]
    s_waitcnt lgkmcnt(0)
    s_barrier
    v_add_u32 v125, 49152, v124
    v_xor_b32 v126, 8, v125
    v_mfma_f32_16x16x32_bf16 v[100:103], v[24:27], v[44:47], v[100:103]
    ds_read_b64_tr_b16 v[36:37], v125 offset:0
    ds_read_b64_tr_b16 v[38:39], v125 offset:2048
    v_mfma_f32_16x16x32_bf16 v[104:107], v[24:27], v[48:51], v[104:107]
    ds_read_b64_tr_b16 v[40:41], v126 offset:0
    ds_read_b64_tr_b16 v[42:43], v126 offset:2048
    v_mfma_f32_16x16x32_bf16 v[108:111], v[28:31], v[44:47], v[108:111]
    v_mfma_f32_16x16x32_bf16 v[112:115], v[28:31], v[48:51], v[112:115]
    v_mfma_f32_16x16x32_bf16 v[116:119], v[32:35], v[44:47], v[116:119]
    v_mfma_f32_16x16x32_bf16 v[120:123], v[32:35], v[48:51], v[120:123]
    s_nop 6
    v_cvt_pk_bf16_f32 v68, v100, v104
    v_cvt_pk_bf16_f32 v69, v101, v105
    v_cvt_pk_bf16_f32 v70, v102, v106
    v_cvt_pk_bf16_f32 v71, v103, v107
    v_lshlrev_b32 v52, 16, v68
    v_and_b32 v53, v10, v68
    v_lshlrev_b32 v54, 16, v69
    v_and_b32 v55, v10, v69
    v_lshlrev_b32 v56, 16, v70
    v_and_b32 v57, v10, v70
    v_lshlrev_b32 v58, 16, v71
    v_and_b32 v59, v10, v71
    v_mul_f32 v60, v11, v52
    v_mul_f32 v61, v11, v53
    v_mul_f32 v62, v11, v54
    v_mul_f32 v63, v11, v55
    v_mul_f32 v64, v11, v56
    v_mul_f32 v65, v11, v57
    v_mul_f32 v66, v11, v58
    v_mul_f32 v67, v11, v59
    v_exp_f32 v60, v60
    v_exp_f32 v61, v61
    v_exp_f32 v62, v62
    v_exp_f32 v63, v63
    v_exp_f32 v64, v64
    v_exp_f32 v65, v65
    v_exp_f32 v66, v66
    v_exp_f32 v67, v67
    v_add_f32 v60, 1.0, v60
    v_add_f32 v61, 1.0, v61
    v_add_f32 v62, 1.0, v62
    v_add_f32 v63, 1.0, v63
    v_add_f32 v64, 1.0, v64
    v_add_f32 v65, 1.0, v65
    v_add_f32 v66, 1.0, v66
    v_add_f32 v67, 1.0, v67
    v_rcp_f32 v60, v60
    v_rcp_f32 v61, v61
    v_rcp_f32 v62, v62
    v_rcp_f32 v63, v63
    v_rcp_f32 v64, v64
    v_rcp_f32 v65, v65
    v_rcp_f32 v66, v66
    v_rcp_f32 v67, v67
    v_mul_f32 v52, v52, v60
    v_mul_f32 v53, v53, v61
    v_mul_f32 v54, v54, v62
    v_mul_f32 v55, v55, v63
    v_mul_f32 v56, v56, v64
    v_mul_f32 v57, v57, v65
    v_mul_f32 v58, v58, v66
    v_mul_f32 v59, v59, v67
    v_cvt_pk_bf16_f32 v68, v52, v53
    v_cvt_pk_bf16_f32 v69, v54, v55
    v_cvt_pk_bf16_f32 v70, v56, v57
    v_cvt_pk_bf16_f32 v71, v58, v59
    v_mov_b32_dpp v60, v68 quad_perm:[1,0,3,2] row_mask:0xf bank_mask:0xf
    v_mov_b32_dpp v61, v69 quad_perm:[1,0,3,2] row_mask:0xf bank_mask:0xf
    v_mov_b32_dpp v62, v70 quad_perm:[1,0,3,2] row_mask:0xf bank_mask:0xf
    v_mov_b32_dpp v63, v71 quad_perm:[1,0,3,2] row_mask:0xf bank_mask:0xf
    v_perm_b32 v68, v60, v68, v127
    v_perm_b32 v69, v61, v69, v127
    v_perm_b32 v70, v62, v70, v127
    v_perm_b32 v71, v63, v71, v127
    ds_write_b32 v6, v68 offset:0
    ds_write_b32 v7, v69 offset:0
    ds_write_b32 v8, v70 offset:0
    ds_write_b32 v9, v71 offset:0
    v_cvt_pk_bf16_f32 v88, v108, v112
    v_cvt_pk_bf16_f32 v89, v109, v113
    v_cvt_pk_bf16_f32 v90, v110, v114
    v_cvt_pk_bf16_f32 v91, v111, v115
    v_lshlrev_b32 v72, 16, v88
    v_and_b32 v73, v10, v88
    v_lshlrev_b32 v74, 16, v89
    v_and_b32 v75, v10, v89
    v_lshlrev_b32 v76, 16, v90
    v_and_b32 v77, v10, v90
    v_lshlrev_b32 v78, 16, v91
    v_and_b32 v79, v10, v91
    v_mul_f32 v80, v11, v72
    v_mul_f32 v81, v11, v73
    v_mul_f32 v82, v11, v74
    v_mul_f32 v83, v11, v75
    v_mul_f32 v84, v11, v76
    v_mul_f32 v85, v11, v77
    v_mul_f32 v86, v11, v78
    v_mul_f32 v87, v11, v79
    v_exp_f32 v80, v80
    v_exp_f32 v81, v81
    v_exp_f32 v82, v82
    v_exp_f32 v83, v83
    v_exp_f32 v84, v84
    v_exp_f32 v85, v85
    v_exp_f32 v86, v86
    v_exp_f32 v87, v87
    v_add_f32 v80, 1.0, v80
    v_add_f32 v81, 1.0, v81
    v_add_f32 v82, 1.0, v82
    v_add_f32 v83, 1.0, v83
    v_add_f32 v84, 1.0, v84
    v_add_f32 v85, 1.0, v85
    v_add_f32 v86, 1.0, v86
    v_add_f32 v87, 1.0, v87
    v_rcp_f32 v80, v80
    v_rcp_f32 v81, v81
    v_rcp_f32 v82, v82
    v_rcp_f32 v83, v83
    v_rcp_f32 v84, v84
    v_rcp_f32 v85, v85
    v_rcp_f32 v86, v86
    v_rcp_f32 v87, v87
    v_mul_f32 v72, v72, v80
    v_mul_f32 v73, v73, v81
    v_mul_f32 v74, v74, v82
    v_mul_f32 v75, v75, v83
    v_mul_f32 v76, v76, v84
    v_mul_f32 v77, v77, v85
    v_mul_f32 v78, v78, v86
    v_mul_f32 v79, v79, v87
    v_cvt_pk_bf16_f32 v88, v72, v73
    v_cvt_pk_bf16_f32 v89, v74, v75
    v_cvt_pk_bf16_f32 v90, v76, v77
    v_cvt_pk_bf16_f32 v91, v78, v79
    v_mov_b32_dpp v80, v88 quad_perm:[1,0,3,2] row_mask:0xf bank_mask:0xf
    v_mov_b32_dpp v81, v89 quad_perm:[1,0,3,2] row_mask:0xf bank_mask:0xf
    v_mov_b32_dpp v82, v90 quad_perm:[1,0,3,2] row_mask:0xf bank_mask:0xf
    v_mov_b32_dpp v83, v91 quad_perm:[1,0,3,2] row_mask:0xf bank_mask:0xf
    v_perm_b32 v88, v80, v88, v127
    v_perm_b32 v89, v81, v89, v127
    v_perm_b32 v90, v82, v90, v127
    v_perm_b32 v91, v83, v91, v127
    ds_write_b32 v6, v88 offset:8192
    ds_write_b32 v7, v89 offset:8192
    ds_write_b32 v8, v90 offset:8192
    ds_write_b32 v9, v91 offset:8192
    v_cvt_pk_bf16_f32 v68, v116, v120
    v_cvt_pk_bf16_f32 v69, v117, v121
    v_cvt_pk_bf16_f32 v70, v118, v122
    v_cvt_pk_bf16_f32 v71, v119, v123
    v_lshlrev_b32 v52, 16, v68
    v_and_b32 v53, v10, v68
    v_lshlrev_b32 v54, 16, v69
    v_and_b32 v55, v10, v69
    v_lshlrev_b32 v56, 16, v70
    v_and_b32 v57, v10, v70
    v_lshlrev_b32 v58, 16, v71
    v_and_b32 v59, v10, v71
    v_mul_f32 v60, v11, v52
    v_mul_f32 v61, v11, v53
    v_mul_f32 v62, v11, v54
    v_mul_f32 v63, v11, v55
    v_mul_f32 v64, v11, v56
    v_mul_f32 v65, v11, v57
    v_mul_f32 v66, v11, v58
    v_mul_f32 v67, v11, v59
    v_exp_f32 v60, v60
    v_exp_f32 v61, v61
    v_exp_f32 v62, v62
    v_exp_f32 v63, v63
    v_exp_f32 v64, v64
    v_exp_f32 v65, v65
    v_exp_f32 v66, v66
    v_exp_f32 v67, v67
    v_add_f32 v60, 1.0, v60
    v_add_f32 v61, 1.0, v61
    v_add_f32 v62, 1.0, v62
    v_add_f32 v63, 1.0, v63
    v_add_f32 v64, 1.0, v64
    v_add_f32 v65, 1.0, v65
    v_add_f32 v66, 1.0, v66
    v_add_f32 v67, 1.0, v67
    v_rcp_f32 v60, v60
    v_rcp_f32 v61, v61
    v_rcp_f32 v62, v62
    v_rcp_f32 v63, v63
    v_rcp_f32 v64, v64
    v_rcp_f32 v65, v65
    v_rcp_f32 v66, v66
    v_rcp_f32 v67, v67
    v_mul_f32 v52, v52, v60
    v_mul_f32 v53, v53, v61
    v_mul_f32 v54, v54, v62
    v_mul_f32 v55, v55, v63
    v_mul_f32 v56, v56, v64
    v_mul_f32 v57, v57, v65
    v_mul_f32 v58, v58, v66
    v_mul_f32 v59, v59, v67
    v_cvt_pk_bf16_f32 v68, v52, v53
    v_cvt_pk_bf16_f32 v69, v54, v55
    v_cvt_pk_bf16_f32 v70, v56, v57
    v_cvt_pk_bf16_f32 v71, v58, v59
    v_mov_b32_dpp v60, v68 quad_perm:[1,0,3,2] row_mask:0xf bank_mask:0xf
    v_mov_b32_dpp v61, v69 quad_perm:[1,0,3,2] row_mask:0xf bank_mask:0xf
    v_mov_b32_dpp v62, v70 quad_perm:[1,0,3,2] row_mask:0xf bank_mask:0xf
    v_mov_b32_dpp v63, v71 quad_perm:[1,0,3,2] row_mask:0xf bank_mask:0xf
    v_perm_b32 v68, v60, v68, v127
    v_perm_b32 v69, v61, v69, v127
    v_perm_b32 v70, v62, v70, v127
    v_perm_b32 v71, v63, v71, v127
    ds_write_b32 v6, v68 offset:16384
    ds_write_b32 v7, v69 offset:16384
    ds_write_b32 v8, v70 offset:16384
    ds_write_b32 v9, v71 offset:16384
    s_waitcnt lgkmcnt(0)
    s_barrier
    ds_read_b128 v[12:15], v2 offset:0
    ds_read_b128 v[16:19], v2 offset:8192
    ds_read_b128 v[20:23], v2 offset:16384
    v_add_u32 v125, 65536, v124
    v_xor_b32 v126, 8, v125
    s_waitcnt lgkmcnt(2)
    v_mfma_f32_16x16x32_bf16 v[52:55], v[12:15], v[36:39], 0
    ds_read_b64_tr_b16 v[44:45], v125 offset:0
    ds_read_b64_tr_b16 v[46:47], v125 offset:2048
    v_mfma_f32_16x16x32_bf16 v[64:67], v[12:15], v[40:43], 0
    ds_read_b64_tr_b16 v[48:49], v126 offset:0
    ds_read_b64_tr_b16 v[50:51], v126 offset:2048
    s_waitcnt lgkmcnt(5)
    v_mfma_f32_16x16x32_bf16 v[56:59], v[16:19], v[36:39], 0
    v_mfma_f32_16x16x32_bf16 v[68:71], v[16:19], v[40:43], 0
    s_waitcnt lgkmcnt(4)
    v_mfma_f32_16x16x32_bf16 v[60:63], v[20:23], v[36:39], 0
    v_mfma_f32_16x16x32_bf16 v[72:75], v[20:23], v[40:43], 0
    s_waitcnt lgkmcnt(0)
    s_barrier
    v_add_u32 v125, 81920, v124
    v_xor_b32 v126, 8, v125
    v_mfma_f32_16x16x32_bf16 v[76:79], v[12:15], v[44:47], 0
    ds_read_b64_tr_b16 v[36:37], v125 offset:0
    ds_read_b64_tr_b16 v[38:39], v125 offset:2048
    v_mfma_f32_16x16x32_bf16 v[88:91], v[12:15], v[48:51], 0
    ds_read_b64_tr_b16 v[40:41], v126 offset:0
    ds_read_b64_tr_b16 v[42:43], v126 offset:2048
    v_mfma_f32_16x16x32_bf16 v[80:83], v[16:19], v[44:47], 0
    ds_read_b128 v[24:27], v3 offset:0
    ds_read_b128 v[28:31], v3 offset:8192
    v_mfma_f32_16x16x32_bf16 v[92:95], v[16:19], v[48:51], 0
    ds_read_b128 v[32:35], v3 offset:16384
    v_mfma_f32_16x16x32_bf16 v[84:87], v[20:23], v[44:47], 0
    v_mfma_f32_16x16x32_bf16 v[96:99], v[20:23], v[48:51], 0
    s_waitcnt lgkmcnt(0)
    v_add_u32 v125, 98304, v124
    v_xor_b32 v126, 8, v125
    v_mfma_f32_16x16x32_bf16 v[100:103], v[12:15], v[36:39], 0
    ds_read_b64_tr_b16 v[44:45], v125 offset:0
    ds_read_b64_tr_b16 v[46:47], v125 offset:2048
    v_mfma_f32_16x16x32_bf16 v[112:115], v[12:15], v[40:43], 0
    ds_read_b64_tr_b16 v[48:49], v126 offset:0
    ds_read_b64_tr_b16 v[50:51], v126 offset:2048
    v_mfma_f32_16x16x32_bf16 v[104:107], v[16:19], v[36:39], 0
    v_mfma_f32_16x16x32_bf16 v[116:119], v[16:19], v[40:43], 0
    v_mfma_f32_16x16x32_bf16 v[108:111], v[20:23], v[36:39], 0
    v_mfma_f32_16x16x32_bf16 v[120:123], v[20:23], v[40:43], 0
    s_waitcnt lgkmcnt(0)
    s_barrier
    v_add_u32 v125, 114688, v124
    v_xor_b32 v126, 8, v125
    v_mfma_f32_16x16x32_bf16 v[52:55], v[24:27], v[44:47], v[52:55]
    ds_read_b64_tr_b16 v[36:37], v125 offset:0
    ds_read_b64_tr_b16 v[38:39], v125 offset:2048
    v_mfma_f32_16x16x32_bf16 v[64:67], v[24:27], v[48:51], v[64:67]
    ds_read_b64_tr_b16 v[40:41], v126 offset:0
    ds_read_b64_tr_b16 v[42:43], v126 offset:2048
    v_mfma_f32_16x16x32_bf16 v[56:59], v[28:31], v[44:47], v[56:59]
    v_mfma_f32_16x16x32_bf16 v[68:71], v[28:31], v[48:51], v[68:71]
    v_mfma_f32_16x16x32_bf16 v[60:63], v[32:35], v[44:47], v[60:63]
    v_mfma_f32_16x16x32_bf16 v[72:75], v[32:35], v[48:51], v[72:75]
    s_waitcnt lgkmcnt(0)
    v_add_u32 v125, 131072, v124
    v_xor_b32 v126, 8, v125
    v_mfma_f32_16x16x32_bf16 v[76:79], v[24:27], v[36:39], v[76:79]
    ds_read_b64_tr_b16 v[44:45], v125 offset:0
    ds_read_b64_tr_b16 v[46:47], v125 offset:2048
    v_mfma_f32_16x16x32_bf16 v[88:91], v[24:27], v[40:43], v[88:91]
    ds_read_b64_tr_b16 v[48:49], v126 offset:0
    ds_read_b64_tr_b16 v[50:51], v126 offset:2048
    v_mfma_f32_16x16x32_bf16 v[80:83], v[28:31], v[36:39], v[80:83]
    ds_read_b128 v[12:15], v4 offset:0
    ds_read_b128 v[16:19], v4 offset:8192
    v_mfma_f32_16x16x32_bf16 v[92:95], v[28:31], v[40:43], v[92:95]
    ds_read_b128 v[20:23], v4 offset:16384
    v_mfma_f32_16x16x32_bf16 v[84:87], v[32:35], v[36:39], v[84:87]
    v_mfma_f32_16x16x32_bf16 v[96:99], v[32:35], v[40:43], v[96:99]
    s_waitcnt lgkmcnt(0)
    s_barrier
    v_add_u32 v125, 147456, v124
    v_xor_b32 v126, 8, v125
    v_mfma_f32_16x16x32_bf16 v[100:103], v[24:27], v[44:47], v[100:103]
    ds_read_b64_tr_b16 v[36:37], v125 offset:0
    ds_read_b64_tr_b16 v[38:39], v125 offset:2048
    v_mfma_f32_16x16x32_bf16 v[112:115], v[24:27], v[48:51], v[112:115]
    ds_read_b64_tr_b16 v[40:41], v126 offset:0
    ds_read_b64_tr_b16 v[42:43], v126 offset:2048
    v_mfma_f32_16x16x32_bf16 v[104:107], v[28:31], v[44:47], v[104:107]
    v_mfma_f32_16x16x32_bf16 v[116:119], v[28:31], v[48:51], v[116:119]
    v_mfma_f32_16x16x32_bf16 v[108:111], v[32:35], v[44:47], v[108:111]
    v_mfma_f32_16x16x32_bf16 v[120:123], v[32:35], v[48:51], v[120:123]
    s_waitcnt lgkmcnt(0)
    v_add_u32 v125, 49152, v124
    v_xor_b32 v126, 8, v125
    v_mfma_f32_16x16x32_bf16 v[52:55], v[12:15], v[36:39], v[52:55]
    ds_read_b64_tr_b16 v[44:45], v125 offset:0
    ds_read_b64_tr_b16 v[46:47], v125 offset:2048
    v_mfma_f32_16x16x32_bf16 v[64:67], v[12:15], v[40:43], v[64:67]
    ds_read_b64_tr_b16 v[48:49], v126 offset:0
    ds_read_b64_tr_b16 v[50:51], v126 offset:2048
    v_mfma_f32_16x16x32_bf16 v[56:59], v[16:19], v[36:39], v[56:59]
    v_mfma_f32_16x16x32_bf16 v[68:71], v[16:19], v[40:43], v[68:71]
    v_mfma_f32_16x16x32_bf16 v[60:63], v[20:23], v[36:39], v[60:63]
    v_mfma_f32_16x16x32_bf16 v[72:75], v[20:23], v[40:43], v[72:75]
    s_waitcnt lgkmcnt(0)
    s_barrier
    v_add_u32 v125, 65536, v124
    v_xor_b32 v126, 8, v125
    v_mfma_f32_16x16x32_bf16 v[76:79], v[12:15], v[44:47], v[76:79]
    ds_read_b64_tr_b16 v[36:37], v125 offset:0
    ds_read_b64_tr_b16 v[38:39], v125 offset:2048
    v_mfma_f32_16x16x32_bf16 v[88:91], v[12:15], v[48:51], v[88:91]
    ds_read_b64_tr_b16 v[40:41], v126 offset:0
    ds_read_b64_tr_b16 v[42:43], v126 offset:2048
    v_mfma_f32_16x16x32_bf16 v[80:83], v[16:19], v[44:47], v[80:83]
    ds_read_b128 v[24:27], v5 offset:0
    ds_read_b128 v[28:31], v5 offset:8192
    v_mfma_f32_16x16x32_bf16 v[92:95], v[16:19], v[48:51], v[92:95]
    ds_read_b128 v[32:35], v5 offset:16384
    v_mfma_f32_16x16x32_bf16 v[84:87], v[20:23], v[44:47], v[84:87]
    v_mfma_f32_16x16x32_bf16 v[96:99], v[20:23], v[48:51], v[96:99]
    s_waitcnt lgkmcnt(0)
    v_add_u32 v125, 81920, v124
    v_xor_b32 v126, 8, v125
    v_mfma_f32_16x16x32_bf16 v[100:103], v[12:15], v[36:39], v[100:103]
    ds_read_b64_tr_b16 v[44:45], v125 offset:0
    ds_read_b64_tr_b16 v[46:47], v125 offset:2048
    v_mfma_f32_16x16x32_bf16 v[112:115], v[12:15], v[40:43], v[112:115]
    ds_read_b64_tr_b16 v[48:49], v126 offset:0
    ds_read_b64_tr_b16 v[50:51], v126 offset:2048
    v_mfma_f32_16x16x32_bf16 v[104:107], v[16:19], v[36:39], v[104:107]
    v_mfma_f32_16x16x32_bf16 v[116:119], v[16:19], v[40:43], v[116:119]
    v_mfma_f32_16x16x32_bf16 v[108:111], v[20:23], v[36:39], v[108:111]
    v_mfma_f32_16x16x32_bf16 v[120:123], v[20:23], v[40:43], v[120:123]
    s_waitcnt lgkmcnt(0)
    s_barrier
    v_add_u32 v125, 98304, v124
    v_xor_b32 v126, 8, v125
    v_mfma_f32_16x16x32_bf16 v[52:55], v[24:27], v[44:47], v[52:55]
    ds_read_b64_tr_b16 v[36:37], v125 offset:0
    ds_read_b64_tr_b16 v[38:39], v125 offset:2048
    v_mfma_f32_16x16x32_bf16 v[64:67], v[24:27], v[48:51], v[64:67]
    ds_read_b64_tr_b16 v[40:41], v126 offset:0
    ds_read_b64_tr_b16 v[42:43], v126 offset:2048
    v_mfma_f32_16x16x32_bf16 v[56:59], v[28:31], v[44:47], v[56:59]
    v_mfma_f32_16x16x32_bf16 v[68:71], v[28:31], v[48:51], v[68:71]
    v_mfma_f32_16x16x32_bf16 v[60:63], v[32:35], v[44:47], v[60:63]
    v_mfma_f32_16x16x32_bf16 v[72:75], v[32:35], v[48:51], v[72:75]
    s_waitcnt lgkmcnt(0)
    v_add_u32 v125, 114688, v124
    v_xor_b32 v126, 8, v125
    v_mfma_f32_16x16x32_bf16 v[76:79], v[24:27], v[36:39], v[76:79]
    ds_read_b64_tr_b16 v[44:45], v125 offset:0
    ds_read_b64_tr_b16 v[46:47], v125 offset:2048
    v_mfma_f32_16x16x32_bf16 v[88:91], v[24:27], v[40:43], v[88:91]
    ds_read_b64_tr_b16 v[48:49], v126 offset:0
    ds_read_b64_tr_b16 v[50:51], v126 offset:2048
    v_mfma_f32_16x16x32_bf16 v[80:83], v[28:31], v[36:39], v[80:83]
    ds_read_b128 v[12:15], v2 offset:256
    ds_read_b128 v[16:19], v2 offset:8448
    v_mfma_f32_16x16x32_bf16 v[92:95], v[28:31], v[40:43], v[92:95]
    ds_read_b128 v[20:23], v2 offset:16640
    v_mfma_f32_16x16x32_bf16 v[84:87], v[32:35], v[36:39], v[84:87]
    v_mfma_f32_16x16x32_bf16 v[96:99], v[32:35], v[40:43], v[96:99]
    s_waitcnt lgkmcnt(0)
    s_barrier
    v_add_u32 v125, 131072, v124
    v_xor_b32 v126, 8, v125
    v_mfma_f32_16x16x32_bf16 v[100:103], v[24:27], v[44:47], v[100:103]
    ds_read_b64_tr_b16 v[36:37], v125 offset:0
    ds_read_b64_tr_b16 v[38:39], v125 offset:2048
    v_mfma_f32_16x16x32_bf16 v[112:115], v[24:27], v[48:51], v[112:115]
    ds_read_b64_tr_b16 v[40:41], v126 offset:0
    ds_read_b64_tr_b16 v[42:43], v126 offset:2048
    v_mfma_f32_16x16x32_bf16 v[104:107], v[28:31], v[44:47], v[104:107]
    v_mfma_f32_16x16x32_bf16 v[116:119], v[28:31], v[48:51], v[116:119]
    v_mfma_f32_16x16x32_bf16 v[108:111], v[32:35], v[44:47], v[108:111]
    v_mfma_f32_16x16x32_bf16 v[120:123], v[32:35], v[48:51], v[120:123]
    s_waitcnt lgkmcnt(0)
    v_add_u32 v125, 147456, v124
    v_xor_b32 v126, 8, v125
    v_mfma_f32_16x16x32_bf16 v[52:55], v[12:15], v[36:39], v[52:55]
    ds_read_b64_tr_b16 v[44:45], v125 offset:0
    ds_read_b64_tr_b16 v[46:47], v125 offset:2048
    v_mfma_f32_16x16x32_bf16 v[64:67], v[12:15], v[40:43], v[64:67]
    ds_read_b64_tr_b16 v[48:49], v126 offset:0
    ds_read_b64_tr_b16 v[50:51], v126 offset:2048
    v_mfma_f32_16x16x32_bf16 v[56:59], v[16:19], v[36:39], v[56:59]
    v_mfma_f32_16x16x32_bf16 v[68:71], v[16:19], v[40:43], v[68:71]
    v_mfma_f32_16x16x32_bf16 v[60:63], v[20:23], v[36:39], v[60:63]
    v_mfma_f32_16x16x32_bf16 v[72:75], v[20:23], v[40:43], v[72:75]
    s_waitcnt lgkmcnt(0)
    s_barrier
    v_add_u32 v125, 49152, v124
    v_xor_b32 v126, 8, v125
    v_mfma_f32_16x16x32_bf16 v[76:79], v[12:15], v[44:47], v[76:79]
    ds_read_b64_tr_b16 v[36:37], v125 offset:0
    ds_read_b64_tr_b16 v[38:39], v125 offset:2048
    v_mfma_f32_16x16x32_bf16 v[88:91], v[12:15], v[48:51], v[88:91]
    ds_read_b64_tr_b16 v[40:41], v126 offset:0
    ds_read_b64_tr_b16 v[42:43], v126 offset:2048
    v_mfma_f32_16x16x32_bf16 v[80:83], v[16:19], v[44:47], v[80:83]
    ds_read_b128 v[24:27], v3 offset:256
    ds_read_b128 v[28:31], v3 offset:8448
    v_mfma_f32_16x16x32_bf16 v[92:95], v[16:19], v[48:51], v[92:95]
    ds_read_b128 v[32:35], v3 offset:16640
    v_mfma_f32_16x16x32_bf16 v[84:87], v[20:23], v[44:47], v[84:87]
    v_mfma_f32_16x16x32_bf16 v[96:99], v[20:23], v[48:51], v[96:99]
    s_waitcnt lgkmcnt(0)
    v_add_u32 v125, 65536, v124
    v_xor_b32 v126, 8, v125
    v_mfma_f32_16x16x32_bf16 v[100:103], v[12:15], v[36:39], v[100:103]
    ds_read_b64_tr_b16 v[44:45], v125 offset:0
    ds_read_b64_tr_b16 v[46:47], v125 offset:2048
    v_mfma_f32_16x16x32_bf16 v[112:115], v[12:15], v[40:43], v[112:115]
    ds_read_b64_tr_b16 v[48:49], v126 offset:0
    ds_read_b64_tr_b16 v[50:51], v126 offset:2048
    v_mfma_f32_16x16x32_bf16 v[104:107], v[16:19], v[36:39], v[104:107]
    v_mfma_f32_16x16x32_bf16 v[116:119], v[16:19], v[40:43], v[116:119]
    v_mfma_f32_16x16x32_bf16 v[108:111], v[20:23], v[36:39], v[108:111]
    v_mfma_f32_16x16x32_bf16 v[120:123], v[20:23], v[40:43], v[120:123]
    s_waitcnt lgkmcnt(0)
    s_barrier
    v_add_u32 v125, 81920, v124
    v_xor_b32 v126, 8, v125
    v_mfma_f32_16x16x32_bf16 v[52:55], v[24:27], v[44:47], v[52:55]
    ds_read_b64_tr_b16 v[36:37], v125 offset:0
    ds_read_b64_tr_b16 v[38:39], v125 offset:2048
    v_mfma_f32_16x16x32_bf16 v[64:67], v[24:27], v[48:51], v[64:67]
    ds_read_b64_tr_b16 v[40:41], v126 offset:0
    ds_read_b64_tr_b16 v[42:43], v126 offset:2048
    v_mfma_f32_16x16x32_bf16 v[56:59], v[28:31], v[44:47], v[56:59]
    v_mfma_f32_16x16x32_bf16 v[68:71], v[28:31], v[48:51], v[68:71]
    v_mfma_f32_16x16x32_bf16 v[60:63], v[32:35], v[44:47], v[60:63]
    v_mfma_f32_16x16x32_bf16 v[72:75], v[32:35], v[48:51], v[72:75]
    s_waitcnt lgkmcnt(0)
    v_add_u32 v125, 98304, v124
    v_xor_b32 v126, 8, v125
    v_mfma_f32_16x16x32_bf16 v[76:79], v[24:27], v[36:39], v[76:79]
    ds_read_b64_tr_b16 v[44:45], v125 offset:0
    ds_read_b64_tr_b16 v[46:47], v125 offset:2048
    v_mfma_f32_16x16x32_bf16 v[88:91], v[24:27], v[40:43], v[88:91]
    ds_read_b64_tr_b16 v[48:49], v126 offset:0
    ds_read_b64_tr_b16 v[50:51], v126 offset:2048
    v_mfma_f32_16x16x32_bf16 v[80:83], v[28:31], v[36:39], v[80:83]
    ds_read_b128 v[12:15], v4 offset:256
    ds_read_b128 v[16:19], v4 offset:8448
    v_mfma_f32_16x16x32_bf16 v[92:95], v[28:31], v[40:43], v[92:95]
    ds_read_b128 v[20:23], v4 offset:16640
    v_mfma_f32_16x16x32_bf16 v[84:87], v[32:35], v[36:39], v[84:87]
    v_mfma_f32_16x16x32_bf16 v[96:99], v[32:35], v[40:43], v[96:99]
    s_waitcnt lgkmcnt(0)
    s_barrier
    v_add_u32 v125, 114688, v124
    v_xor_b32 v126, 8, v125
    v_mfma_f32_16x16x32_bf16 v[100:103], v[24:27], v[44:47], v[100:103]
    ds_read_b64_tr_b16 v[36:37], v125 offset:0
    ds_read_b64_tr_b16 v[38:39], v125 offset:2048
    v_mfma_f32_16x16x32_bf16 v[112:115], v[24:27], v[48:51], v[112:115]
    ds_read_b64_tr_b16 v[40:41], v126 offset:0
    ds_read_b64_tr_b16 v[42:43], v126 offset:2048
    v_mfma_f32_16x16x32_bf16 v[104:107], v[28:31], v[44:47], v[104:107]
    v_mfma_f32_16x16x32_bf16 v[116:119], v[28:31], v[48:51], v[116:119]
    v_mfma_f32_16x16x32_bf16 v[108:111], v[32:35], v[44:47], v[108:111]
    v_mfma_f32_16x16x32_bf16 v[120:123], v[32:35], v[48:51], v[120:123]
    s_waitcnt lgkmcnt(0)
    v_add_u32 v125, 131072, v124
    v_xor_b32 v126, 8, v125
    v_mfma_f32_16x16x32_bf16 v[52:55], v[12:15], v[36:39], v[52:55]
    ds_read_b64_tr_b16 v[44:45], v125 offset:0
    ds_read_b64_tr_b16 v[46:47], v125 offset:2048
    v_mfma_f32_16x16x32_bf16 v[64:67], v[12:15], v[40:43], v[64:67]
    ds_read_b64_tr_b16 v[48:49], v126 offset:0
    ds_read_b64_tr_b16 v[50:51], v126 offset:2048
    v_mfma_f32_16x16x32_bf16 v[56:59], v[16:19], v[36:39], v[56:59]
    v_mfma_f32_16x16x32_bf16 v[68:71], v[16:19], v[40:43], v[68:71]
    v_mfma_f32_16x16x32_bf16 v[60:63], v[20:23], v[36:39], v[60:63]
    v_mfma_f32_16x16x32_bf16 v[72:75], v[20:23], v[40:43], v[72:75]
    s_waitcnt lgkmcnt(0)
    s_barrier
    v_add_u32 v125, 147456, v124
    v_xor_b32 v126, 8, v125
    v_mfma_f32_16x16x32_bf16 v[76:79], v[12:15], v[44:47], v[76:79]
    ds_read_b64_tr_b16 v[36:37], v125 offset:0
    ds_read_b64_tr_b16 v[38:39], v125 offset:2048
    v_mfma_f32_16x16x32_bf16 v[88:91], v[12:15], v[48:51], v[88:91]
    ds_read_b64_tr_b16 v[40:41], v126 offset:0
    ds_read_b64_tr_b16 v[42:43], v126 offset:2048
    v_mfma_f32_16x16x32_bf16 v[80:83], v[16:19], v[44:47], v[80:83]
    ds_read_b128 v[24:27], v5 offset:256
    ds_read_b128 v[28:31], v5 offset:8448
    v_mfma_f32_16x16x32_bf16 v[92:95], v[16:19], v[48:51], v[92:95]
    ds_read_b128 v[32:35], v5 offset:16640
    v_mfma_f32_16x16x32_bf16 v[84:87], v[20:23], v[44:47], v[84:87]
    v_mfma_f32_16x16x32_bf16 v[96:99], v[20:23], v[48:51], v[96:99]
    s_waitcnt lgkmcnt(0)
    v_add_u32 v125, 49152, v124
    v_xor_b32 v126, 8, v125
    v_mfma_f32_16x16x32_bf16 v[100:103], v[12:15], v[36:39], v[100:103]
    ds_read_b64_tr_b16 v[44:45], v125 offset:0
    ds_read_b64_tr_b16 v[46:47], v125 offset:2048
    v_mfma_f32_16x16x32_bf16 v[112:115], v[12:15], v[40:43], v[112:115]
    ds_read_b64_tr_b16 v[48:49], v126 offset:0
    ds_read_b64_tr_b16 v[50:51], v126 offset:2048
    v_mfma_f32_16x16x32_bf16 v[104:107], v[16:19], v[36:39], v[104:107]
    v_mfma_f32_16x16x32_bf16 v[116:119], v[16:19], v[40:43], v[116:119]
    v_mfma_f32_16x16x32_bf16 v[108:111], v[20:23], v[36:39], v[108:111]
    v_mfma_f32_16x16x32_bf16 v[120:123], v[20:23], v[40:43], v[120:123]
    s_waitcnt lgkmcnt(0)
    v_add_u32 v125, 65536, v124
    v_xor_b32 v126, 8, v125
    v_mfma_f32_16x16x32_bf16 v[52:55], v[24:27], v[44:47], v[52:55]
    ds_read_b64_tr_b16 v[36:37], v125 offset:0
    ds_read_b64_tr_b16 v[38:39], v125 offset:2048
    v_mfma_f32_16x16x32_bf16 v[64:67], v[24:27], v[48:51], v[64:67]
    ds_read_b64_tr_b16 v[40:41], v126 offset:0
    ds_read_b64_tr_b16 v[42:43], v126 offset:2048
    v_mfma_f32_16x16x32_bf16 v[56:59], v[28:31], v[44:47], v[56:59]
    v_mfma_f32_16x16x32_bf16 v[68:71], v[28:31], v[48:51], v[68:71]
    v_mfma_f32_16x16x32_bf16 v[60:63], v[32:35], v[44:47], v[60:63]
    v_mfma_f32_16x16x32_bf16 v[72:75], v[32:35], v[48:51], v[72:75]
    s_waitcnt lgkmcnt(0)
    v_add_u32 v125, 81920, v124
    v_xor_b32 v126, 8, v125
    v_mfma_f32_16x16x32_bf16 v[76:79], v[24:27], v[36:39], v[76:79]
    ds_read_b64_tr_b16 v[44:45], v125 offset:0
    ds_read_b64_tr_b16 v[46:47], v125 offset:2048
    v_mfma_f32_16x16x32_bf16 v[88:91], v[24:27], v[40:43], v[88:91]
    ds_read_b64_tr_b16 v[48:49], v126 offset:0
    ds_read_b64_tr_b16 v[50:51], v126 offset:2048
    v_mfma_f32_16x16x32_bf16 v[80:83], v[28:31], v[36:39], v[80:83]
    v_mfma_f32_16x16x32_bf16 v[92:95], v[28:31], v[40:43], v[92:95]
    v_mfma_f32_16x16x32_bf16 v[84:87], v[32:35], v[36:39], v[84:87]
    v_mfma_f32_16x16x32_bf16 v[96:99], v[32:35], v[40:43], v[96:99]
    s_waitcnt lgkmcnt(0)
    v_mfma_f32_16x16x32_bf16 v[100:103], v[24:27], v[44:47], v[100:103]
    v_mfma_f32_16x16x32_bf16 v[112:115], v[24:27], v[48:51], v[112:115]
    v_mfma_f32_16x16x32_bf16 v[104:107], v[28:31], v[44:47], v[104:107]
    v_mfma_f32_16x16x32_bf16 v[116:119], v[28:31], v[48:51], v[116:119]
    v_mfma_f32_16x16x32_bf16 v[108:111], v[32:35], v[44:47], v[108:111]
    v_mfma_f32_16x16x32_bf16 v[120:123], v[32:35], v[48:51], v[120:123]
    s_setprio 3
    s_barrier
    v_add_u32 v2, 98304, v6
    v_add_u32 v3, 98304, v7
    v_add_u32 v4, 98304, v8
    v_add_u32 v5, 98304, v9
    ds_read_b32 v12, v6 offset:24576
    ds_read_b32 v24, v2 offset:0
    ds_read_b32 v36, v2 offset:24576
    ds_read_b32 v13, v7 offset:24576
    ds_read_b32 v25, v3 offset:0
    ds_read_b32 v37, v3 offset:24576
    ds_read_b32 v14, v8 offset:24576
    ds_read_b32 v26, v4 offset:0
    ds_read_b32 v38, v4 offset:24576
    ds_read_b32 v15, v9 offset:24576
    ds_read_b32 v27, v5 offset:0
    ds_read_b32 v39, v5 offset:24576
    ds_read_b32 v16, v6 offset:32768
    ds_read_b32 v28, v2 offset:8192
    ds_read_b32 v40, v2 offset:32768
    ds_read_b32 v17, v7 offset:32768
    ds_read_b32 v29, v3 offset:8192
    ds_read_b32 v41, v3 offset:32768
    ds_read_b32 v18, v8 offset:32768
    ds_read_b32 v30, v4 offset:8192
    ds_read_b32 v42, v4 offset:32768
    ds_read_b32 v19, v9 offset:32768
    ds_read_b32 v31, v5 offset:8192
    ds_read_b32 v43, v5 offset:32768
    ds_read_b32 v20, v6 offset:40960
    ds_read_b32 v32, v2 offset:16384
    ds_read_b32 v44, v2 offset:40960
    ds_read_b32 v21, v7 offset:40960
    ds_read_b32 v33, v3 offset:16384
    ds_read_b32 v45, v3 offset:40960
    ds_read_b32 v22, v8 offset:40960
    ds_read_b32 v34, v4 offset:16384
    ds_read_b32 v46, v4 offset:40960
    ds_read_b32 v23, v9 offset:40960
    ds_read_b32 v35, v5 offset:16384
    ds_read_b32 v47, v5 offset:40960
    v_cvt_pk_bf16_f32 v76, v76, v88
    v_cvt_pk_bf16_f32 v77, v77, v89
    v_cvt_pk_bf16_f32 v78, v78, v90
    v_cvt_pk_bf16_f32 v79, v79, v91
    v_mov_b32_dpp v88, v76 quad_perm:[1,0,3,2] row_mask:0xf bank_mask:0xf
    v_mov_b32_dpp v89, v77 quad_perm:[1,0,3,2] row_mask:0xf bank_mask:0xf
    v_mov_b32_dpp v90, v78 quad_perm:[1,0,3,2] row_mask:0xf bank_mask:0xf
    v_mov_b32_dpp v91, v79 quad_perm:[1,0,3,2] row_mask:0xf bank_mask:0xf
    v_cvt_pk_bf16_f32 v100, v100, v112
    v_cvt_pk_bf16_f32 v101, v101, v113
    v_cvt_pk_bf16_f32 v102, v102, v114
    v_cvt_pk_bf16_f32 v103, v103, v115
    v_mov_b32_dpp v112, v100 quad_perm:[1,0,3,2] row_mask:0xf bank_mask:0xf
    v_mov_b32_dpp v113, v101 quad_perm:[1,0,3,2] row_mask:0xf bank_mask:0xf
    v_mov_b32_dpp v114, v102 quad_perm:[1,0,3,2] row_mask:0xf bank_mask:0xf
    v_mov_b32_dpp v115, v103 quad_perm:[1,0,3,2] row_mask:0xf bank_mask:0xf
    s_waitcnt lgkmcnt(0)
    s_barrier
    v_cvt_pk_bf16_f32 v52, v52, v64
    v_cvt_pk_bf16_f32 v53, v53, v65
    v_cvt_pk_bf16_f32 v54, v54, v66
    v_cvt_pk_bf16_f32 v55, v55, v67
    v_mov_b32_dpp v64, v52 quad_perm:[1,0,3,2] row_mask:0xf bank_mask:0xf
    v_mov_b32_dpp v65, v53 quad_perm:[1,0,3,2] row_mask:0xf bank_mask:0xf
    v_mov_b32_dpp v66, v54 quad_perm:[1,0,3,2] row_mask:0xf bank_mask:0xf
    v_mov_b32_dpp v67, v55 quad_perm:[1,0,3,2] row_mask:0xf bank_mask:0xf
    v_perm_b32 v52, v64, v52, v127
    v_perm_b32 v53, v65, v53, v127
    v_perm_b32 v54, v66, v54, v127
    v_perm_b32 v55, v67, v55, v127
    buffer_store_dword v52, v1, s[36:39], s48 offen offset:0 sc1
    buffer_store_dword v53, v1, s[36:39], s48 offen offset:128 sc1
    buffer_store_dword v54, v1, s[36:39], s48 offen offset:256 sc1
    buffer_store_dword v55, v1, s[36:39], s48 offen offset:384 sc1
    s_add_u32 s48, s48, 2048
    v_cvt_pk_bf16_f32 v56, v56, v68
    v_cvt_pk_bf16_f32 v57, v57, v69
    v_cvt_pk_bf16_f32 v58, v58, v70
    v_cvt_pk_bf16_f32 v59, v59, v71
    v_mov_b32_dpp v68, v56 quad_perm:[1,0,3,2] row_mask:0xf bank_mask:0xf
    v_mov_b32_dpp v69, v57 quad_perm:[1,0,3,2] row_mask:0xf bank_mask:0xf
    v_mov_b32_dpp v70, v58 quad_perm:[1,0,3,2] row_mask:0xf bank_mask:0xf
    v_mov_b32_dpp v71, v59 quad_perm:[1,0,3,2] row_mask:0xf bank_mask:0xf
    v_perm_b32 v56, v68, v56, v127
    v_perm_b32 v57, v69, v57, v127
    v_perm_b32 v58, v70, v58, v127
    v_perm_b32 v59, v71, v59, v127
    buffer_store_dword v56, v1, s[36:39], s48 offen offset:0 sc1
    buffer_store_dword v57, v1, s[36:39], s48 offen offset:128 sc1
    buffer_store_dword v58, v1, s[36:39], s48 offen offset:256 sc1
    buffer_store_dword v59, v1, s[36:39], s48 offen offset:384 sc1
    s_add_u32 s48, s48, 2048
    v_cvt_pk_bf16_f32 v60, v60, v72
    v_cvt_pk_bf16_f32 v61, v61, v73
    v_cvt_pk_bf16_f32 v62, v62, v74
    v_cvt_pk_bf16_f32 v63, v63, v75
    v_mov_b32_dpp v72, v60 quad_perm:[1,0,3,2] row_mask:0xf bank_mask:0xf
    v_mov_b32_dpp v73, v61 quad_perm:[1,0,3,2] row_mask:0xf bank_mask:0xf
    v_mov_b32_dpp v74, v62 quad_perm:[1,0,3,2] row_mask:0xf bank_mask:0xf
    v_mov_b32_dpp v75, v63 quad_perm:[1,0,3,2] row_mask:0xf bank_mask:0xf
    v_perm_b32 v60, v72, v60, v127
    v_perm_b32 v61, v73, v61, v127
    v_perm_b32 v62, v74, v62, v127
    v_perm_b32 v63, v75, v63, v127
    buffer_store_dword v60, v1, s[36:39], s48 offen offset:0 sc1
    buffer_store_dword v61, v1, s[36:39], s48 offen offset:128 sc1
    buffer_store_dword v62, v1, s[36:39], s48 offen offset:256 sc1
    buffer_store_dword v63, v1, s[36:39], s48 offen offset:384 sc1
    s_add_u32 s48, s48, 2048
    v_perm_b32 v61, v88, v76, v127
    v_perm_b32 v52, v112, v100, v127
    v_lshlrev_b32 v62, 16, v12
    v_and_b32 v63, v10, v12
    v_lshlrev_b32 v64, 16, v24
    v_and_b32 v65, v10, v24
    v_lshlrev_b32 v66, 16, v36
    v_and_b32 v67, v10, v36
    v_lshlrev_b32 v60, 16, v61
    v_and_b32 v61, v10, v61
    v_mul_f32 v62, v60, v62
    v_mul_f32 v63, v61, v63
    v_mul_f32 v64, v60, v64
    v_mul_f32 v65, v61, v65
    v_mul_f32 v66, v60, v66
    v_mul_f32 v67, v61, v67
    v_cvt_pk_bf16_f32 v60, v62, v64
    v_cvt_pk_bf16_f32 v61, v66, v66
    v_perm_b32 v53, v63, v60, s50
    v_perm_b32 v54, v65, v60, s51
    v_perm_b32 v55, v67, v61, s50
    buffer_store_dwordx4 v[52:55], v0, s[36:39], s47 offen offset:0 sc1
    v_perm_b32 v69, v89, v77, v127
    v_perm_b32 v56, v113, v101, v127
    v_lshlrev_b32 v70, 16, v13
    v_and_b32 v71, v10, v13
    v_lshlrev_b32 v72, 16, v25
    v_and_b32 v73, v10, v25
    v_lshlrev_b32 v74, 16, v37
    v_and_b32 v75, v10, v37
    v_lshlrev_b32 v68, 16, v69
    v_and_b32 v69, v10, v69
    v_mul_f32 v70, v68, v70
    v_mul_f32 v71, v69, v71
    v_mul_f32 v72, v68, v72
    v_mul_f32 v73, v69, v73
    v_mul_f32 v74, v68, v74
    v_mul_f32 v75, v69, v75
    v_cvt_pk_bf16_f32 v68, v70, v72
    v_cvt_pk_bf16_f32 v69, v74, v74
    v_perm_b32 v57, v71, v68, s50
    v_perm_b32 v58, v73, v68, s51
    v_perm_b32 v59, v75, v69, s50
    buffer_store_dwordx4 v[56:59], v0, s[36:39], s47 offen offset:256 sc1
    v_perm_b32 v61, v90, v78, v127
    v_perm_b32 v52, v114, v102, v127
    v_lshlrev_b32 v62, 16, v14
    v_and_b32 v63, v10, v14
    v_lshlrev_b32 v64, 16, v26
    v_and_b32 v65, v10, v26
    v_lshlrev_b32 v66, 16, v38
    v_and_b32 v67, v10, v38
    v_lshlrev_b32 v60, 16, v61
    v_and_b32 v61, v10, v61
    v_mul_f32 v62, v60, v62
    v_mul_f32 v63, v61, v63
    v_mul_f32 v64, v60, v64
    v_mul_f32 v65, v61, v65
    v_mul_f32 v66, v60, v66
    v_mul_f32 v67, v61, v67
    v_cvt_pk_bf16_f32 v60, v62, v64
    v_cvt_pk_bf16_f32 v61, v66, v66
    v_perm_b32 v53, v63, v60, s50
    v_perm_b32 v54, v65, v60, s51
    v_perm_b32 v55, v67, v61, s50
    buffer_store_dwordx4 v[52:55], v0, s[36:39], s47 offen offset:512 sc1
    v_perm_b32 v69, v91, v79, v127
    v_perm_b32 v56, v115, v103, v127
    v_lshlrev_b32 v70, 16, v15
    v_and_b32 v71, v10, v15
    v_lshlrev_b32 v72, 16, v27
    v_and_b32 v73, v10, v27
    v_lshlrev_b32 v74, 16, v39
    v_and_b32 v75, v10, v39
    v_lshlrev_b32 v68, 16, v69
    v_and_b32 v69, v10, v69
    v_mul_f32 v70, v68, v70
    v_mul_f32 v71, v69, v71
    v_mul_f32 v72, v68, v72
    v_mul_f32 v73, v69, v73
    v_mul_f32 v74, v68, v74
    v_mul_f32 v75, v69, v75
    v_cvt_pk_bf16_f32 v68, v70, v72
    v_cvt_pk_bf16_f32 v69, v74, v74
    v_perm_b32 v57, v71, v68, s50
    v_perm_b32 v58, v73, v68, s51
    v_perm_b32 v59, v75, v69, s50
    buffer_store_dwordx4 v[56:59], v0, s[36:39], s47 offen offset:768 sc1
    s_add_u32 s47, s47, 4096
    v_cvt_pk_bf16_f32 v80, v80, v92
    v_cvt_pk_bf16_f32 v81, v81, v93
    v_cvt_pk_bf16_f32 v82, v82, v94
    v_cvt_pk_bf16_f32 v83, v83, v95
    v_mov_b32_dpp v92, v80 quad_perm:[1,0,3,2] row_mask:0xf bank_mask:0xf
    v_mov_b32_dpp v93, v81 quad_perm:[1,0,3,2] row_mask:0xf bank_mask:0xf
    v_mov_b32_dpp v94, v82 quad_perm:[1,0,3,2] row_mask:0xf bank_mask:0xf
    v_mov_b32_dpp v95, v83 quad_perm:[1,0,3,2] row_mask:0xf bank_mask:0xf
    v_cvt_pk_bf16_f32 v104, v104, v116
    v_cvt_pk_bf16_f32 v105, v105, v117
    v_cvt_pk_bf16_f32 v106, v106, v118
    v_cvt_pk_bf16_f32 v107, v107, v119
    v_mov_b32_dpp v116, v104 quad_perm:[1,0,3,2] row_mask:0xf bank_mask:0xf
    v_mov_b32_dpp v117, v105 quad_perm:[1,0,3,2] row_mask:0xf bank_mask:0xf
    v_mov_b32_dpp v118, v106 quad_perm:[1,0,3,2] row_mask:0xf bank_mask:0xf
    v_mov_b32_dpp v119, v107 quad_perm:[1,0,3,2] row_mask:0xf bank_mask:0xf
    v_perm_b32 v61, v92, v80, v127
    v_perm_b32 v52, v116, v104, v127
    v_lshlrev_b32 v62, 16, v16
    v_and_b32 v63, v10, v16
    v_lshlrev_b32 v64, 16, v28
    v_and_b32 v65, v10, v28
    v_lshlrev_b32 v66, 16, v40
    v_and_b32 v67, v10, v40
    v_lshlrev_b32 v60, 16, v61
    v_and_b32 v61, v10, v61
    v_mul_f32 v62, v60, v62
    v_mul_f32 v63, v61, v63
    v_mul_f32 v64, v60, v64
    v_mul_f32 v65, v61, v65
    v_mul_f32 v66, v60, v66
    v_mul_f32 v67, v61, v67
    v_cvt_pk_bf16_f32 v60, v62, v64
    v_cvt_pk_bf16_f32 v61, v66, v66
    v_perm_b32 v53, v63, v60, s50
    v_perm_b32 v54, v65, v60, s51
    v_perm_b32 v55, v67, v61, s50
    buffer_store_dwordx4 v[52:55], v0, s[36:39], s47 offen offset:0 sc1
    v_perm_b32 v69, v93, v81, v127
    v_perm_b32 v56, v117, v105, v127
    v_lshlrev_b32 v70, 16, v17
    v_and_b32 v71, v10, v17
    v_lshlrev_b32 v72, 16, v29
    v_and_b32 v73, v10, v29
    v_lshlrev_b32 v74, 16, v41
    v_and_b32 v75, v10, v41
    v_lshlrev_b32 v68, 16, v69
    v_and_b32 v69, v10, v69
    v_mul_f32 v70, v68, v70
    v_mul_f32 v71, v69, v71
    v_mul_f32 v72, v68, v72
    v_mul_f32 v73, v69, v73
    v_mul_f32 v74, v68, v74
    v_mul_f32 v75, v69, v75
    v_cvt_pk_bf16_f32 v68, v70, v72
    v_cvt_pk_bf16_f32 v69, v74, v74
    v_perm_b32 v57, v71, v68, s50
    v_perm_b32 v58, v73, v68, s51
    v_perm_b32 v59, v75, v69, s50
    buffer_store_dwordx4 v[56:59], v0, s[36:39], s47 offen offset:256 sc1
    v_perm_b32 v61, v94, v82, v127
    v_perm_b32 v52, v118, v106, v127
    v_lshlrev_b32 v62, 16, v18
    v_and_b32 v63, v10, v18
    v_lshlrev_b32 v64, 16, v30
    v_and_b32 v65, v10, v30
    v_lshlrev_b32 v66, 16, v42
    v_and_b32 v67, v10, v42
    v_lshlrev_b32 v60, 16, v61
    v_and_b32 v61, v10, v61
    v_mul_f32 v62, v60, v62
    v_mul_f32 v63, v61, v63
    v_mul_f32 v64, v60, v64
    v_mul_f32 v65, v61, v65
    v_mul_f32 v66, v60, v66
    v_mul_f32 v67, v61, v67
    v_cvt_pk_bf16_f32 v60, v62, v64
    v_cvt_pk_bf16_f32 v61, v66, v66
    v_perm_b32 v53, v63, v60, s50
    v_perm_b32 v54, v65, v60, s51
    v_perm_b32 v55, v67, v61, s50
    buffer_store_dwordx4 v[52:55], v0, s[36:39], s47 offen offset:512 sc1
    v_perm_b32 v69, v95, v83, v127
    v_perm_b32 v56, v119, v107, v127
    v_lshlrev_b32 v70, 16, v19
    v_and_b32 v71, v10, v19
    v_lshlrev_b32 v72, 16, v31
    v_and_b32 v73, v10, v31
    v_lshlrev_b32 v74, 16, v43
    v_and_b32 v75, v10, v43
    v_lshlrev_b32 v68, 16, v69
    v_and_b32 v69, v10, v69
    v_mul_f32 v70, v68, v70
    v_mul_f32 v71, v69, v71
    v_mul_f32 v72, v68, v72
    v_mul_f32 v73, v69, v73
    v_mul_f32 v74, v68, v74
    v_mul_f32 v75, v69, v75
    v_cvt_pk_bf16_f32 v68, v70, v72
    v_cvt_pk_bf16_f32 v69, v74, v74
    v_perm_b32 v57, v71, v68, s50
    v_perm_b32 v58, v73, v68, s51
    v_perm_b32 v59, v75, v69, s50
    buffer_store_dwordx4 v[56:59], v0, s[36:39], s47 offen offset:768 sc1
    s_add_u32 s47, s47, 4096
    v_cvt_pk_bf16_f32 v84, v84, v96
    v_cvt_pk_bf16_f32 v85, v85, v97
    v_cvt_pk_bf16_f32 v86, v86, v98
    v_cvt_pk_bf16_f32 v87, v87, v99
    v_mov_b32_dpp v96, v84 quad_perm:[1,0,3,2] row_mask:0xf bank_mask:0xf
    v_mov_b32_dpp v97, v85 quad_perm:[1,0,3,2] row_mask:0xf bank_mask:0xf
    v_mov_b32_dpp v98, v86 quad_perm:[1,0,3,2] row_mask:0xf bank_mask:0xf
    v_mov_b32_dpp v99, v87 quad_perm:[1,0,3,2] row_mask:0xf bank_mask:0xf
    v_cvt_pk_bf16_f32 v108, v108, v120
    v_cvt_pk_bf16_f32 v109, v109, v121
    v_cvt_pk_bf16_f32 v110, v110, v122
    v_cvt_pk_bf16_f32 v111, v111, v123
    v_mov_b32_dpp v120, v108 quad_perm:[1,0,3,2] row_mask:0xf bank_mask:0xf
    v_mov_b32_dpp v121, v109 quad_perm:[1,0,3,2] row_mask:0xf bank_mask:0xf
    v_mov_b32_dpp v122, v110 quad_perm:[1,0,3,2] row_mask:0xf bank_mask:0xf
    v_mov_b32_dpp v123, v111 quad_perm:[1,0,3,2] row_mask:0xf bank_mask:0xf
    v_perm_b32 v61, v96, v84, v127
    v_perm_b32 v52, v120, v108, v127
    v_lshlrev_b32 v62, 16, v20
    v_and_b32 v63, v10, v20
    v_lshlrev_b32 v64, 16, v32
    v_and_b32 v65, v10, v32
    v_lshlrev_b32 v66, 16, v44
    v_and_b32 v67, v10, v44
    v_lshlrev_b32 v60, 16, v61
    v_and_b32 v61, v10, v61
    v_mul_f32 v62, v60, v62
    v_mul_f32 v63, v61, v63
    v_mul_f32 v64, v60, v64
    v_mul_f32 v65, v61, v65
    v_mul_f32 v66, v60, v66
    v_mul_f32 v67, v61, v67
    v_cvt_pk_bf16_f32 v60, v62, v64
    v_cvt_pk_bf16_f32 v61, v66, v66
    v_perm_b32 v53, v63, v60, s50
    v_perm_b32 v54, v65, v60, s51
    v_perm_b32 v55, v67, v61, s50
    buffer_store_dwordx4 v[52:55], v0, s[36:39], s47 offen offset:0 sc1
    v_perm_b32 v69, v97, v85, v127
    v_perm_b32 v56, v121, v109, v127
    v_lshlrev_b32 v70, 16, v21
    v_and_b32 v71, v10, v21
    v_lshlrev_b32 v72, 16, v33
    v_and_b32 v73, v10, v33
    v_lshlrev_b32 v74, 16, v45
    v_and_b32 v75, v10, v45
    v_lshlrev_b32 v68, 16, v69
    v_and_b32 v69, v10, v69
    v_mul_f32 v70, v68, v70
    v_mul_f32 v71, v69, v71
    v_mul_f32 v72, v68, v72
    v_mul_f32 v73, v69, v73
    v_mul_f32 v74, v68, v74
    v_mul_f32 v75, v69, v75
    v_cvt_pk_bf16_f32 v68, v70, v72
    v_cvt_pk_bf16_f32 v69, v74, v74
    v_perm_b32 v57, v71, v68, s50
    v_perm_b32 v58, v73, v68, s51
    v_perm_b32 v59, v75, v69, s50
    buffer_store_dwordx4 v[56:59], v0, s[36:39], s47 offen offset:256 sc1
    v_perm_b32 v61, v98, v86, v127
    v_perm_b32 v52, v122, v110, v127
    v_lshlrev_b32 v62, 16, v22
    v_and_b32 v63, v10, v22
    v_lshlrev_b32 v64, 16, v34
    v_and_b32 v65, v10, v34
    v_lshlrev_b32 v66, 16, v46
    v_and_b32 v67, v10, v46
    v_lshlrev_b32 v60, 16, v61
    v_and_b32 v61, v10, v61
    v_mul_f32 v62, v60, v62
    v_mul_f32 v63, v61, v63
    v_mul_f32 v64, v60, v64
    v_mul_f32 v65, v61, v65
    v_mul_f32 v66, v60, v66
    v_mul_f32 v67, v61, v67
    v_cvt_pk_bf16_f32 v60, v62, v64
    v_cvt_pk_bf16_f32 v61, v66, v66
    v_perm_b32 v53, v63, v60, s50
    v_perm_b32 v54, v65, v60, s51
    v_perm_b32 v55, v67, v61, s50
    buffer_store_dwordx4 v[52:55], v0, s[36:39], s47 offen offset:512 sc1
    v_perm_b32 v69, v99, v87, v127
    v_perm_b32 v56, v123, v111, v127
    v_lshlrev_b32 v70, 16, v23
    v_and_b32 v71, v10, v23
    v_lshlrev_b32 v72, 16, v35
    v_and_b32 v73, v10, v35
    v_lshlrev_b32 v74, 16, v47
    v_and_b32 v75, v10, v47
    v_lshlrev_b32 v68, 16, v69
    v_and_b32 v69, v10, v69
    v_mul_f32 v70, v68, v70
    v_mul_f32 v71, v69, v71
    v_mul_f32 v72, v68, v72
    v_mul_f32 v73, v69, v73
    v_mul_f32 v74, v68, v74
    v_mul_f32 v75, v69, v75
    v_cvt_pk_bf16_f32 v68, v70, v72
    v_cvt_pk_bf16_f32 v69, v74, v74
    v_perm_b32 v57, v71, v68, s50
    v_perm_b32 v58, v73, v68, s51
    v_perm_b32 v59, v75, v69, s50
    buffer_store_dwordx4 v[56:59], v0, s[36:39], s47 offen offset:768 sc1
    s_setprio 0
    s_waitcnt vmcnt(0)
    v_mov_b32 v2, 162816
    v_mov_b32 v3, 1
    s_mov_b64 exec, 1
    ds_add_rtn_u32 v4, v2, v3
    s_waitcnt lgkmcnt(0)
    v_readfirstlane_b32 s60, v4
    s_mov_b64 exec, -1
    s_cmp_lg_u32 s60, 7
    s_cbranch_scc1 K2_START
    ds_read_b32 v3, v2 offset:16
    s_lshl_b32 s60, s2, 5
    s_add_u32 s60, s60, 0x18b0000
    v_mov_b32 v4, 0
    s_waitcnt lgkmcnt(0)
    s_mov_b64 exec, 1
    buffer_store_dword v3, v4, s[36:39], s60 offen sc1
    v_mov_b32 v3, 1
    ds_add_u32 v2, v3
    s_mov_b64 exec, -1
    s_branch K2_START
K1_IDLE:
    s_waitcnt lgkmcnt(0)
    s_mov_b32 s36, s22
    s_mov_b32 s37, s23
    s_mov_b32 s38, 0x10000000
    s_mov_b32 s39, 0x20000
    s_barrier
    s_barrier
    s_mov_b32 s80, 0x18b7f80
    s_load_dword s80, s[22:23], s80
    s_barrier
    s_barrier
    s_barrier
    s_barrier
    s_barrier
    s_barrier
    s_barrier
    s_barrier
    s_barrier
    s_barrier
    s_waitcnt lgkmcnt(0)
    s_mul_i32 s80, s80, 0x9e3779b1
    s_add_u32 s80, s80, 0x7f4a7c15
    s_barrier
    s_barrier
    s_barrier
    s_barrier
    s_barrier
    s_cmp_lg_u32 s3, 12
    s_cbranch_scc1 K1_NT
    v_mov_b32 v6, 162816
    v_mov_b32 v7, s80
    ds_write_b32 v6, v7 offset:16
    v_mov_b32 v8, 0
    v_mov_b32 v9, 0
    v_mov_b32 v10, 0
    v_mov_b32 v11, 0
    ds_write_b128 v6, v[8:11]
    s_waitcnt lgkmcnt(0)
K1_NT:
    s_barrier
    s_branch K2_START
K1_EDGE:
    s_cmp_ge_u32 s3, 12
    s_cbranch_scc1 K1_PF
    s_sub_u32 s44, s2, 209
    s_mul_i32 s45, s3, 5120
    v_lshlrev_b32 v3, 4, v2
    s_mul_i32 s47, s44, 13620
    v_lshlrev_b32 v4, 2, v0
    s_waitcnt lgkmcnt(0)
    s_mov_b32 s28, s8
    s_mov_b32 s29, s9
    s_mov_b32 s30, 0x9c400
    s_mov_b32 s31, 0x20000
    s_mov_b32 s32, s10
    s_mov_b32 s33, s11
    s_mov_b32 s34, 0x9c400
    s_mov_b32 s35, 0x20000
    buffer_load_dword v8, v4, s[28:31], s47 offen offset:0
    buffer_load_dword v16, v4, s[32:35], s47 offen offset:0
    buffer_load_dword v9, v4, s[28:31], s47 offen offset:3072
    buffer_load_dword v17, v4, s[32:35], s47 offen offset:3072
    s_add_u32 s47, s47, 6144
    buffer_load_dword v10, v4, s[28:31], s47 offen offset:0
    buffer_load_dword v18, v4, s[32:35], s47 offen offset:0
    buffer_load_dword v11, v4, s[28:31], s47 offen offset:3072
    buffer_load_dword v19, v4, s[32:35], s47 offen offset:3072
    s_add_u32 s47, s47, 6144
    buffer_load_dword v12, v4, s[28:31], s47 offen offset:0
    buffer_load_dword v20, v4, s[32:35], s47 offen offset:0
    s_mov_b32 s24, s6
    s_mov_b32 s25, s7
    s_mov_b32 s26, 0xea60
    s_mov_b32 s27, 0x20000
    s_add_u32 s46, s45, 0
    s_add_u32 m0, s46, 256
    s_nop 0
    buffer_load_dwordx4 v3, s[24:27], s46 offen offset:0 lds
    buffer_load_dwordx4 v3, s[24:27], s46 offen offset:1024 lds
    buffer_load_dwordx4 v3, s[24:27], s46 offen offset:2048 lds
    buffer_load_dwordx4 v3, s[24:27], s46 offen offset:3072 lds
    s_add_u32 s46, s45, 4096
    s_add_u32 m0, s46, 256
    s_nop 0
    buffer_load_dwordx4 v3, s[24:27], s46 offen offset:0 lds
    s_cmp_lg_u32 s44, 32
    s_cbranch_scc1 K1_NB1
    s_cmp_ge_u32 s3, 8
    s_cbranch_scc1 K1_NB1
    s_mov_b32 s40, s18
    s_mov_b32 s41, s19
    s_mov_b32 s42, 0x6000
    s_mov_b32 s43, 0x20000
    v_lshrrev_b32 v28, 4, v2
    v_and_b32 v29, 15, v2
    v_mul_u32_u24 v28, 6144, v28
    v_lshrrev_b32 v30, 1, v29
    v_and_b32 v31, 1, v29
    v_lshl_add_u32 v30, v31, 3, v30
    v_lshl_add_u32 v27, v29, 2, v28
    v_lshl_add_u32 v28, v29, 2, v28
    s_lshl_b32 s56, s3, 6
    s_and_b32 s57, s56, 0x180
    buffer_load_dword v104, v27, s[40:43], s56 offen offset:512
    buffer_load_dword v108, v27, s[40:43], s56 offen offset:1024
    buffer_load_dword v112, v28, s[40:43], s57 offen offset:0
    buffer_load_dword v116, v28, s[40:43], s57 offen offset:64
    buffer_load_dword v105, v27, s[40:43], s56 offen offset:2048
    buffer_load_dword v109, v27, s[40:43], s56 offen offset:2560
    buffer_load_dword v113, v28, s[40:43], s57 offen offset:1536
    buffer_load_dword v117, v28, s[40:43], s57 offen offset:1600
    s_add_u32 s56, s56, 3072
    s_add_u32 s57, s57, 3072
    buffer_load_dword v106, v27, s[40:43], s56 offen offset:512
    buffer_load_dword v110, v27, s[40:43], s56 offen offset:1024
    buffer_load_dword v114, v28, s[40:43], s57 offen offset:0
    buffer_load_dword v118, v28, s[40:43], s57 offen offset:64
    buffer_load_dword v107, v27, s[40:43], s56 offen offset:2048
    buffer_load_dword v111, v27, s[40:43], s56 offen offset:2560
    buffer_load_dword v115, v28, s[40:43], s57 offen offset:1536
    buffer_load_dword v119, v28, s[40:43], s57 offen offset:1600
K1_NB1:
    s_mov_b32 s40, s12
    s_mov_b32 s41, s13
    s_mov_b32 s42, 0x20
    s_mov_b32 s43, 0x20000
    s_mov_b32 s36, s22
    s_mov_b32 s37, s23
    s_mov_b32 s38, 0x10000000
    s_mov_b32 s39, 0x20000
    v_and_b32 v5, 7, v0
    v_lshlrev_b32 v5, 2, v5
    buffer_load_dword v6, v5, s[40:43], 0 offen
    v_mov_b32 v7, 0
    v_and_b32 v5, 0xfc, v4
    ds_write_b32 v5, v7 offset:0
    v_and_b32 v5, 12, v4
    v_add_u32 v5, 162816, v5
    ds_write_b32 v5, v7
    s_mul_i32 s48, s44, 3405
    s_sub_u32 s48, 160000, s48
    s_min_u32 s48, s48, 3405
    v_mov_b32 v24, 0xffff0000
    v_mov_b32 v25, 1
    v_mov_b32 v26, 0x10000
    s_mov_b32 s50, 0x40490fdb
    s_mov_b32 s51, 0x3e4ccccd
    s_mov_b32 s52, 0x322bcc77
    s_mov_b32 s53, 0x409d0000
    s_mul_i32 s54, s44, 2629632
    s_add_u32 s54, s54, 25952256
    s_mov_b32 s55, 41088
    s_cmp_ge_u32 s3, 8
    s_cbranch_scc1 K1_SIDE
    s_cmp_ge_u32 s44, 32
    s_cbranch_scc1 K1_NOLUT
    s_lshl_b32 s56, s44, 9
    v_add_u32 v28, s56, v0
    v_lshrrev_b32 v29, 3, v28
    v_cmp_eq_u32 vcc, 1, v29
    v_sub_u32 v30, 0x40a0, v29
    v_mov_b32 v31, 0x38d2
    v_cndmask_b32 v30, v30, v31, vcc
    v_lshlrev_b32 v30, 16, v30
    v_mul_f32 v31, s50, v30
    v_cvt_pk_bf16_f32 v31, v31, v31
    v_and_b32 v31, v24, v31
    v_mul_f32 v31, s51, v31
    v_cvt_pk_bf16_f32 v31, v31, v31
    v_and_b32 v31, v24, v31
    v_mul_f32 v31, 0.15915494, v31
    v_cos_f32 v31, v31
    s_nop 0
    v_cvt_pk_bf16_f32 v31, v31, v31
    v_and_b32 v31, v24, v31
    v_add_f32 v31, 1.0, v31
    v_cvt_pk_bf16_f32 v31, v31, v31
    v_and_b32 v31, v24, v31
    v_mul_f32 v31, 0.5, v31
    v_rcp_f32 v32, v30
    v_cmp_ne_u32 vcc, 0, v29
    s_waitcnt vmcnt(0)
    v_lshlrev_b32 v33, 16, v6
    v_and_b32 v34, v24, v6
    v_cndmask_b32 v31, 0, v31, vcc
    v_mul_f32 v33, v30, v33
    v_mul_f32 v34, v30, v34
    v_cvt_pk_bf16_f32 v33, v33, v33
    v_and_b32 v33, v24, v33
    v_mul_f32 v33, 0.15915494, v33
    v_fract_f32 v33, v33
    v_sin_f32 v33, v33
    s_nop 0
    v_cvt_pk_bf16_f32 v33, v33, v33
    v_and_b32 v33, v24, v33
    v_mul_f32 v33, v33, v32
    v_cvt_pk_bf16_f32 v33, v33, v33
    v_and_b32 v33, v24, v33
    v_mul_f32 v33, v33, v31
    v_cvt_pk_bf16_f32 v34, v34, v34
    v_and_b32 v34, v24, v34
    v_mul_f32 v34, 0.15915494, v34
    v_fract_f32 v34, v34
    v_sin_f32 v34, v34
    s_nop 0
    v_cvt_pk_bf16_f32 v34, v34, v34
    v_and_b32 v34, v24, v34
    v_mul_f32 v34, v34, v32
    v_cvt_pk_bf16_f32 v34, v34, v34
    v_and_b32 v34, v24, v34
    v_mul_f32 v34, v34, v31
    v_cvt_pk_bf16_f32 v33, v33, v34
    v_lshlrev_b32 v28, 2, v28
    s_mov_b32 s56, 0x1890000
    buffer_store_dword v33, v28, s[36:39], s56 offen sc1
    s_waitcnt vmcnt(1) lgkmcnt(0)
    s_branch K1_SID2
K1_NOLUT:
K1_SIDE:
    s_waitcnt vmcnt(0) lgkmcnt(0)
K1_SID2:
    s_barrier
    s_mov_b32 s80, 0x18b7f80
    s_load_dword s80, s[22:23], s80
    v_mul_u32_u24 v28, 6, v8
    v_and_b32 v28, -4, v28
    ds_read2_b32 v[36:37], v28 offset0:64 offset1:65
    v_mul_u32_u24 v28, 6, v16
    v_and_b32 v28, -4, v28
    ds_read2_b32 v[38:39], v28 offset0:64 offset1:65
    v_mul_u32_u24 v28, 6, v9
    v_and_b32 v28, -4, v28
    ds_read2_b32 v[40:41], v28 offset0:64 offset1:65
    v_mul_u32_u24 v28, 6, v17
    v_and_b32 v28, -4, v28
    ds_read2_b32 v[42:43], v28 offset0:64 offset1:65
    v_mul_u32_u24 v28, 6, v10
    v_and_b32 v28, -4, v28
    ds_read2_b32 v[44:45], v28 offset0:64 offset1:65
    v_mul_u32_u24 v28, 6, v18
    v_and_b32 v28, -4, v28
    ds_read2_b32 v[46:47], v28 offset0:64 offset1:65
    v_mul_u32_u24 v28, 6, v11
    v_and_b32 v28, -4, v28
    ds_read2_b32 v[48:49], v28 offset0:64 offset1:65
    v_mul_u32_u24 v28, 6, v19
    v_and_b32 v28, -4, v28
    ds_read2_b32 v[50:51], v28 offset0:64 offset1:65
    v_mul_u32_u24 v28, 6, v12
    v_and_b32 v28, -4, v28
    ds_read2_b32 v[52:53], v28 offset0:64 offset1:65
    v_mul_u32_u24 v28, 6, v20
    v_and_b32 v28, -4, v28
    ds_read2_b32 v[54:55], v28 offset0:64 offset1:65
    s_cmp_lg_u32 s44, 32
    s_cbranch_scc1 K1_NB2
    s_cmp_ge_u32 s3, 8
    s_cbranch_scc1 K1_NB2
    s_mov_b32 s56, 0x5040100
    s_mov_b32 s57, 0x7060302
    s_lshl_b32 s58, s3, 12
    s_add_u32 s58, s58, 0x18a8000
    v_perm_b32 v64, v105, v104, s56
    v_perm_b32 v66, v105, v104, s57
    v_perm_b32 v65, v107, v106, s56
    v_perm_b32 v67, v107, v106, s57
    buffer_store_dwordx4 v[64:67], v3, s[36:39], s58 offen offset:0 sc1
    v_perm_b32 v68, v109, v108, s56
    v_perm_b32 v70, v109, v108, s57
    v_perm_b32 v69, v111, v110, s56
    v_perm_b32 v71, v111, v110, s57
    buffer_store_dwordx4 v[68:71], v3, s[36:39], s58 offen offset:1024 sc1
    v_perm_b32 v72, v113, v112, s56
    v_perm_b32 v74, v113, v112, s57
    v_perm_b32 v73, v115, v114, s56
    v_perm_b32 v75, v115, v114, s57
    buffer_store_dwordx4 v[72:75], v3, s[36:39], s58 offen offset:2048 sc1
    v_perm_b32 v76, v117, v116, s56
    v_perm_b32 v78, v117, v116, s57
    v_perm_b32 v77, v119, v118, s56
    v_perm_b32 v79, v119, v118, s57
    buffer_store_dwordx4 v[76:79], v3, s[36:39], s58 offen offset:3072 sc1
K1_NB2:
    s_waitcnt lgkmcnt(0)
    v_lshlrev_b32 v28, 4, v8
    v_and_b32 v28, 16, v28
    v_alignbit_b32 v29, v37, v36, v28
    v_lshrrev_b32 v30, v28, v37
    v_lshlrev_b32 v96, 16, v29
    v_and_b32 v97, v24, v29
    v_lshlrev_b32 v98, 16, v30
    v_lshlrev_b32 v28, 4, v16
    v_and_b32 v28, 16, v28
    v_alignbit_b32 v29, v39, v38, v28
    v_lshrrev_b32 v30, v28, v39
    v_lshlrev_b32 v99, 16, v29
    v_and_b32 v100, v24, v29
    v_lshlrev_b32 v101, 16, v30
    v_sub_f32 v96, v96, v99
    v_sub_f32 v97, v97, v100
    v_sub_f32 v98, v98, v101
    v_cvt_pk_bf16_f32 v28, v96, v97
    v_cvt_pk_bf16_f32 v98, v98, v98
    v_and_b32 v98, v24, v98
    v_lshlrev_b32 v96, 16, v28
    v_and_b32 v97, v24, v28
    v_mul_f32 v99, v96, v96
    v_mul_f32 v100, v97, v97
    v_mul_f32 v101, v98, v98
    v_cvt_pk_bf16_f32 v28, v99, v100
    v_cvt_pk_bf16_f32 v101, v101, v101
    v_and_b32 v101, v24, v101
    v_lshlrev_b32 v99, 16, v28
    v_and_b32 v100, v24, v28
    v_add_f32 v28, v99, v100
    v_add_f32 v28, v28, v101
    v_cvt_pk_bf16_f32 v28, v28, v28
    v_and_b32 v28, v24, v28
    v_add_f32 v28, s52, v28
    v_cvt_pk_bf16_f32 v28, v28, v28
    v_and_b32 v28, v24, v28
    v_sqrt_f32 v28, v28
    s_nop 0
    v_cvt_pk_bf16_f32 v28, v28, v28
    v_and_b32 v28, v24, v28
    v_rcp_f32 v29, v28
    s_nop 0
    v_mul_f32 v96, v96, v29
    v_mul_f32 v97, v97, v29
    v_mul_f32 v98, v98, v29
    v_cvt_pk_bf16_f32 v64, v96, v97
    v_cvt_pk_bf16_f32 v65, v98, 0
    v_cmp_eq_u32 vcc, 0x38d20000, v28
    v_sub_u32 v31, 0x40a00000, v28
    v_lshrrev_b32 v29, 6, v16
    v_cndmask_b32 v31, v31, v26, vcc
    v_lshl_or_b32 v66, v29, 16, v8
    v_lshl_or_b32 v65, v31, 5, v65
    s_sub_i32 s57, s48, 0
    v_cmp_gt_i32 s[60:61], s57, v0
    v_cmp_gt_f32 vcc, s53, v28
    s_and_b64 s[60:61], s[60:61], vcc
    v_and_b32 v16, 63, v16
    v_lshlrev_b32 v31, 2, v16
    v_mov_b32 v67, 0
    s_mov_b64 exec, s[60:61]
    ds_add_rtn_u32 v67, v31, v25 offset:0
    s_mov_b64 exec, -1
    v_lshlrev_b32 v28, 4, v9
    v_and_b32 v28, 16, v28
    v_alignbit_b32 v29, v41, v40, v28
    v_lshrrev_b32 v30, v28, v41
    v_lshlrev_b32 v96, 16, v29
    v_and_b32 v97, v24, v29
    v_lshlrev_b32 v98, 16, v30
    v_lshlrev_b32 v28, 4, v17
    v_and_b32 v28, 16, v28
    v_alignbit_b32 v29, v43, v42, v28
    v_lshrrev_b32 v30, v28, v43
    v_lshlrev_b32 v99, 16, v29
    v_and_b32 v100, v24, v29
    v_lshlrev_b32 v101, 16, v30
    v_sub_f32 v96, v96, v99
    v_sub_f32 v97, v97, v100
    v_sub_f32 v98, v98, v101
    v_cvt_pk_bf16_f32 v28, v96, v97
    v_cvt_pk_bf16_f32 v98, v98, v98
    v_and_b32 v98, v24, v98
    v_lshlrev_b32 v96, 16, v28
    v_and_b32 v97, v24, v28
    v_mul_f32 v99, v96, v96
    v_mul_f32 v100, v97, v97
    v_mul_f32 v101, v98, v98
    v_cvt_pk_bf16_f32 v28, v99, v100
    v_cvt_pk_bf16_f32 v101, v101, v101
    v_and_b32 v101, v24, v101
    v_lshlrev_b32 v99, 16, v28
    v_and_b32 v100, v24, v28
    v_add_f32 v28, v99, v100
    v_add_f32 v28, v28, v101
    v_cvt_pk_bf16_f32 v28, v28, v28
    v_and_b32 v28, v24, v28
    v_add_f32 v28, s52, v28
    v_cvt_pk_bf16_f32 v28, v28, v28
    v_and_b32 v28, v24, v28
    v_sqrt_f32 v28, v28
    s_nop 0
    v_cvt_pk_bf16_f32 v28, v28, v28
    v_and_b32 v28, v24, v28
    v_rcp_f32 v29, v28
    s_nop 0
    v_mul_f32 v96, v96, v29
    v_mul_f32 v97, v97, v29
    v_mul_f32 v98, v98, v29
    v_cvt_pk_bf16_f32 v68, v96, v97
    v_cvt_pk_bf16_f32 v69, v98, 0
    v_cmp_eq_u32 vcc, 0x38d20000, v28
    v_sub_u32 v31, 0x40a00000, v28
    v_lshrrev_b32 v29, 6, v17
    v_cndmask_b32 v31, v31, v26, vcc
    v_lshl_or_b32 v70, v29, 16, v9
    v_lshl_or_b32 v69, v31, 5, v69
    s_sub_i32 s57, s48, 768
    v_cmp_gt_i32 s[62:63], s57, v0
    v_cmp_gt_f32 vcc, s53, v28
    s_and_b64 s[62:63], s[62:63], vcc
    v_and_b32 v17, 63, v17
    v_lshlrev_b32 v31, 2, v17
    v_mov_b32 v71, 0
    s_mov_b64 exec, s[62:63]
    ds_add_rtn_u32 v71, v31, v25 offset:0
    s_mov_b64 exec, -1
    v_lshlrev_b32 v28, 4, v10
    v_and_b32 v28, 16, v28
    v_alignbit_b32 v29, v45, v44, v28
    v_lshrrev_b32 v30, v28, v45
    v_lshlrev_b32 v96, 16, v29
    v_and_b32 v97, v24, v29
    v_lshlrev_b32 v98, 16, v30
    v_lshlrev_b32 v28, 4, v18
    v_and_b32 v28, 16, v28
    v_alignbit_b32 v29, v47, v46, v28
    v_lshrrev_b32 v30, v28, v47
    v_lshlrev_b32 v99, 16, v29
    v_and_b32 v100, v24, v29
    v_lshlrev_b32 v101, 16, v30
    v_sub_f32 v96, v96, v99
    v_sub_f32 v97, v97, v100
    v_sub_f32 v98, v98, v101
    v_cvt_pk_bf16_f32 v28, v96, v97
    v_cvt_pk_bf16_f32 v98, v98, v98
    v_and_b32 v98, v24, v98
    v_lshlrev_b32 v96, 16, v28
    v_and_b32 v97, v24, v28
    v_mul_f32 v99, v96, v96
    v_mul_f32 v100, v97, v97
    v_mul_f32 v101, v98, v98
    v_cvt_pk_bf16_f32 v28, v99, v100
    v_cvt_pk_bf16_f32 v101, v101, v101
    v_and_b32 v101, v24, v101
    v_lshlrev_b32 v99, 16, v28
    v_and_b32 v100, v24, v28
    v_add_f32 v28, v99, v100
    v_add_f32 v28, v28, v101
    v_cvt_pk_bf16_f32 v28, v28, v28
    v_and_b32 v28, v24, v28
    v_add_f32 v28, s52, v28
    v_cvt_pk_bf16_f32 v28, v28, v28
    v_and_b32 v28, v24, v28
    v_sqrt_f32 v28, v28
    s_nop 0
    v_cvt_pk_bf16_f32 v28, v28, v28
    v_and_b32 v28, v24, v28
    v_rcp_f32 v29, v28
    s_nop 0
    v_mul_f32 v96, v96, v29
    v_mul_f32 v97, v97, v29
    v_mul_f32 v98, v98, v29
    v_cvt_pk_bf16_f32 v72, v96, v97
    v_cvt_pk_bf16_f32 v73, v98, 0
    v_cmp_eq_u32 vcc, 0x38d20000, v28
    v_sub_u32 v31, 0x40a00000, v28
    v_lshrrev_b32 v29, 6, v18
    v_cndmask_b32 v31, v31, v26, vcc
    v_lshl_or_b32 v74, v29, 16, v10
    v_lshl_or_b32 v73, v31, 5, v73
    s_sub_i32 s57, s48, 1536
    v_cmp_gt_i32 s[64:65], s57, v0
    v_cmp_gt_f32 vcc, s53, v28
    s_and_b64 s[64:65], s[64:65], vcc
    v_and_b32 v18, 63, v18
    v_lshlrev_b32 v31, 2, v18
    v_mov_b32 v75, 0
    s_mov_b64 exec, s[64:65]
    ds_add_rtn_u32 v75, v31, v25 offset:0
    s_mov_b64 exec, -1
    v_lshlrev_b32 v28, 4, v11
    v_and_b32 v28, 16, v28
    v_alignbit_b32 v29, v49, v48, v28
    v_lshrrev_b32 v30, v28, v49
    v_lshlrev_b32 v96, 16, v29
    v_and_b32 v97, v24, v29
    v_lshlrev_b32 v98, 16, v30
    v_lshlrev_b32 v28, 4, v19
    v_and_b32 v28, 16, v28
    v_alignbit_b32 v29, v51, v50, v28
    v_lshrrev_b32 v30, v28, v51
    v_lshlrev_b32 v99, 16, v29
    v_and_b32 v100, v24, v29
    v_lshlrev_b32 v101, 16, v30
    v_sub_f32 v96, v96, v99
    v_sub_f32 v97, v97, v100
    v_sub_f32 v98, v98, v101
    v_cvt_pk_bf16_f32 v28, v96, v97
    v_cvt_pk_bf16_f32 v98, v98, v98
    v_and_b32 v98, v24, v98
    v_lshlrev_b32 v96, 16, v28
    v_and_b32 v97, v24, v28
    v_mul_f32 v99, v96, v96
    v_mul_f32 v100, v97, v97
    v_mul_f32 v101, v98, v98
    v_cvt_pk_bf16_f32 v28, v99, v100
    v_cvt_pk_bf16_f32 v101, v101, v101
    v_and_b32 v101, v24, v101
    v_lshlrev_b32 v99, 16, v28
    v_and_b32 v100, v24, v28
    v_add_f32 v28, v99, v100
    v_add_f32 v28, v28, v101
    v_cvt_pk_bf16_f32 v28, v28, v28
    v_and_b32 v28, v24, v28
    v_add_f32 v28, s52, v28
    v_cvt_pk_bf16_f32 v28, v28, v28
    v_and_b32 v28, v24, v28
    v_sqrt_f32 v28, v28
    s_nop 0
    v_cvt_pk_bf16_f32 v28, v28, v28
    v_and_b32 v28, v24, v28
    v_rcp_f32 v29, v28
    s_nop 0
    v_mul_f32 v96, v96, v29
    v_mul_f32 v97, v97, v29
    v_mul_f32 v98, v98, v29
    v_cvt_pk_bf16_f32 v76, v96, v97
    v_cvt_pk_bf16_f32 v77, v98, 0
    v_cmp_eq_u32 vcc, 0x38d20000, v28
    v_sub_u32 v31, 0x40a00000, v28
    v_lshrrev_b32 v29, 6, v19
    v_cndmask_b32 v31, v31, v26, vcc
    v_lshl_or_b32 v78, v29, 16, v11
    v_lshl_or_b32 v77, v31, 5, v77
    s_sub_i32 s57, s48, 2304
    v_cmp_gt_i32 s[66:67], s57, v0
    v_cmp_gt_f32 vcc, s53, v28
    s_and_b64 s[66:67], s[66:67], vcc
    v_and_b32 v19, 63, v19
    v_lshlrev_b32 v31, 2, v19
    v_mov_b32 v79, 0
    s_mov_b64 exec, s[66:67]
    ds_add_rtn_u32 v79, v31, v25 offset:0
    s_mov_b64 exec, -1
    v_lshlrev_b32 v28, 4, v12
    v_and_b32 v28, 16, v28
    v_alignbit_b32 v29, v53, v52, v28
    v_lshrrev_b32 v30, v28, v53
    v_lshlrev_b32 v96, 16, v29
    v_and_b32 v97, v24, v29
    v_lshlrev_b32 v98, 16, v30
    v_lshlrev_b32 v28, 4, v20
    v_and_b32 v28, 16, v28
    v_alignbit_b32 v29, v55, v54, v28
    v_lshrrev_b32 v30, v28, v55
    v_lshlrev_b32 v99, 16, v29
    v_and_b32 v100, v24, v29
    v_lshlrev_b32 v101, 16, v30
    v_sub_f32 v96, v96, v99
    v_sub_f32 v97, v97, v100
    v_sub_f32 v98, v98, v101
    v_cvt_pk_bf16_f32 v28, v96, v97
    v_cvt_pk_bf16_f32 v98, v98, v98
    v_and_b32 v98, v24, v98
    v_lshlrev_b32 v96, 16, v28
    v_and_b32 v97, v24, v28
    v_mul_f32 v99, v96, v96
    v_mul_f32 v100, v97, v97
    v_mul_f32 v101, v98, v98
    v_cvt_pk_bf16_f32 v28, v99, v100
    v_cvt_pk_bf16_f32 v101, v101, v101
    v_and_b32 v101, v24, v101
    v_lshlrev_b32 v99, 16, v28
    v_and_b32 v100, v24, v28
    v_add_f32 v28, v99, v100
    v_add_f32 v28, v28, v101
    v_cvt_pk_bf16_f32 v28, v28, v28
    v_and_b32 v28, v24, v28
    v_add_f32 v28, s52, v28
    v_cvt_pk_bf16_f32 v28, v28, v28
    v_and_b32 v28, v24, v28
    v_sqrt_f32 v28, v28
    s_nop 0
    v_cvt_pk_bf16_f32 v28, v28, v28
    v_and_b32 v28, v24, v28
    v_rcp_f32 v29, v28
    s_nop 0
    v_mul_f32 v96, v96, v29
    v_mul_f32 v97, v97, v29
    v_mul_f32 v98, v98, v29
    v_cvt_pk_bf16_f32 v80, v96, v97
    v_cvt_pk_bf16_f32 v81, v98, 0
    v_cmp_eq_u32 vcc, 0x38d20000, v28
    v_sub_u32 v31, 0x40a00000, v28
    v_lshrrev_b32 v29, 6, v20
    v_cndmask_b32 v31, v31, v26, vcc
    v_lshl_or_b32 v82, v29, 16, v12
    v_lshl_or_b32 v81, v31, 5, v81
    s_sub_i32 s57, s48, 3072
    v_cmp_gt_i32 s[68:69], s57, v0
    v_cmp_gt_f32 vcc, s53, v28
    s_and_b64 s[68:69], s[68:69], vcc
    v_and_b32 v20, 63, v20
    v_lshlrev_b32 v31, 2, v20
    v_mov_b32 v83, 0
    s_mov_b64 exec, s[68:69]
    ds_add_rtn_u32 v83, v31, v25 offset:0
    s_mov_b64 exec, -1
    s_waitcnt lgkmcnt(0)
    s_movk_i32 s57, 768
    v_cmp_gt_u32 vcc, 64, v67
    v_mul_u32_u24 v28, 12, v67
    v_mad_u32_u24 v29, v16, s57, v28
    v_add_u32 v29, 65536, v29
    s_and_b64 exec, s[60:61], vcc
    ds_write2_b32 v29, v64, v65 offset0:0 offset1:1
    ds_write_b32 v29, v66 offset:8
    s_andn2_b64 exec, s[60:61], vcc
    s_cbranch_execz K1_OV_1
    v_mad_u32_u24 v28, v16, s55, v28
    buffer_store_dwordx3 v[64:66], v28, s[36:39], s54 offen sc1
K1_OV_1:
    s_mov_b64 exec, -1
    v_cmp_gt_u32 vcc, 64, v71
    v_mul_u32_u24 v28, 12, v71
    v_mad_u32_u24 v29, v17, s57, v28
    v_add_u32 v29, 65536, v29
    s_and_b64 exec, s[62:63], vcc
    ds_write2_b32 v29, v68, v69 offset0:0 offset1:1
    ds_write_b32 v29, v70 offset:8
    s_andn2_b64 exec, s[62:63], vcc
    s_cbranch_execz K1_OV_2
    v_mad_u32_u24 v28, v17, s55, v28
    buffer_store_dwordx3 v[68:70], v28, s[36:39], s54 offen sc1
K1_OV_2:
    s_mov_b64 exec, -1
    v_cmp_gt_u32 vcc, 64, v75
    v_mul_u32_u24 v28, 12, v75
    v_mad_u32_u24 v29, v18, s57, v28
    v_add_u32 v29, 65536, v29
    s_and_b64 exec, s[64:65], vcc
    ds_write2_b32 v29, v72, v73 offset0:0 offset1:1
    ds_write_b32 v29, v74 offset:8
    s_andn2_b64 exec, s[64:65], vcc
    s_cbranch_execz K1_OV_3
    v_mad_u32_u24 v28, v18, s55, v28
    buffer_store_dwordx3 v[72:74], v28, s[36:39], s54 offen sc1
K1_OV_3:
    s_mov_b64 exec, -1
    v_cmp_gt_u32 vcc, 64, v79
    v_mul_u32_u24 v28, 12, v79
    v_mad_u32_u24 v29, v19, s57, v28
    v_add_u32 v29, 65536, v29
    s_and_b64 exec, s[66:67], vcc
    ds_write2_b32 v29, v76, v77 offset0:0 offset1:1
    ds_write_b32 v29, v78 offset:8
    s_andn2_b64 exec, s[66:67], vcc
    s_cbranch_execz K1_OV_4
    v_mad_u32_u24 v28, v19, s55, v28
    buffer_store_dwordx3 v[76:78], v28, s[36:39], s54 offen sc1
K1_OV_4:
    s_mov_b64 exec, -1
    v_cmp_gt_u32 vcc, 64, v83
    v_mul_u32_u24 v28, 12, v83
    v_mad_u32_u24 v29, v20, s57, v28
    v_add_u32 v29, 65536, v29
    s_and_b64 exec, s[68:69], vcc
    ds_write2_b32 v29, v80, v81 offset0:0 offset1:1
    ds_write_b32 v29, v82 offset:8
    s_andn2_b64 exec, s[68:69], vcc
    s_cbranch_execz K1_OV_5
    v_mad_u32_u24 v28, v20, s55, v28
    buffer_store_dwordx3 v[80:82], v28, s[36:39], s54 offen sc1
K1_OV_5:
    s_mov_b64 exec, -1
    v_mov_b32 v28, 162816
    s_waitcnt lgkmcnt(0)
    s_mov_b64 exec, 1
    ds_add_u32 v28, v25 offset:12
    s_mov_b64 exec, -1
    v_lshlrev_b32 v30, 2, v2
K1_EW:
    ds_read_b32 v29, v28 offset:12
    s_waitcnt lgkmcnt(0)
    v_cmp_gt_u32 vcc, 12, v29
    s_cbranch_vccnz K1_EW
    ds_read_b32 v31, v30 offset:0
    s_mul_i32 s56, s3, 768
    v_add_u32 v28, s56, v3
    v_add_u32 v28, 65536, v28
    ds_read_b128 v[36:39], v28 offset:0
    ds_read_b128 v[40:43], v28 offset:9216
    ds_read_b128 v[44:47], v28 offset:18432
    ds_read_b128 v[48:51], v28 offset:27648
    ds_read_b128 v[52:55], v28 offset:36864
    ds_read_b128 v[56:59], v28 offset:46080
    s_mul_i32 s56, s3, 41088
    s_add_u32 s56, s56, s54
    s_mov_b32 s58, s3
    v_mov_b32 v30, 0x80000000
    s_waitcnt lgkmcnt(0)
    v_min_u32 v29, 64, v31
    v_mul_u32_u24 v29, 12, v29
    s_nop 0
    v_readlane_b32 s59, v29, s58
    s_add_u32 s58, s58, 12
    s_nop 0
    v_cmp_gt_u32 vcc, s59, v3
    s_nop 1
    v_cndmask_b32 v28, v30, v3, vcc
    buffer_store_dwordx4 v[36:39], v28, s[36:39], s56 offen sc1
    s_add_u32 s56, s56, 493056
    s_nop 0
    v_readlane_b32 s59, v29, s58
    s_add_u32 s58, s58, 12
    s_nop 0
    v_cmp_gt_u32 vcc, s59, v3
    s_nop 1
    v_cndmask_b32 v28, v30, v3, vcc
    buffer_store_dwordx4 v[40:43], v28, s[36:39], s56 offen sc1
    s_add_u32 s56, s56, 493056
    s_nop 0
    v_readlane_b32 s59, v29, s58
    s_add_u32 s58, s58, 12
    s_nop 0
    v_cmp_gt_u32 vcc, s59, v3
    s_nop 1
    v_cndmask_b32 v28, v30, v3, vcc
    buffer_store_dwordx4 v[44:47], v28, s[36:39], s56 offen sc1
    s_add_u32 s56, s56, 493056
    s_nop 0
    v_readlane_b32 s59, v29, s58
    s_add_u32 s58, s58, 12
    s_nop 0
    v_cmp_gt_u32 vcc, s59, v3
    s_nop 1
    v_cndmask_b32 v28, v30, v3, vcc
    buffer_store_dwordx4 v[48:51], v28, s[36:39], s56 offen sc1
    s_add_u32 s56, s56, 493056
    s_nop 0
    v_readlane_b32 s59, v29, s58
    s_add_u32 s58, s58, 12
    s_nop 0
    v_cmp_gt_u32 vcc, s59, v3
    s_nop 1
    v_cndmask_b32 v28, v30, v3, vcc
    buffer_store_dwordx4 v[52:55], v28, s[36:39], s56 offen sc1
    s_add_u32 s56, s56, 493056
    s_cmp_ge_u32 s3, 4
    s_cbranch_scc1 K1_CD
    s_nop 0
    v_readlane_b32 s59, v29, s58
    s_add_u32 s58, s58, 12
    s_nop 0
    v_cmp_gt_u32 vcc, s59, v3
    s_nop 1
    v_cndmask_b32 v28, v30, v3, vcc
    buffer_store_dwordx4 v[56:59], v28, s[36:39], s56 offen sc1
    s_add_u32 s56, s56, 493056
K1_CD:
    v_lshlrev_b32 v29, 9, v2
    s_waitcnt vmcnt(0)
    v_mov_b32 v2, 162816
    v_mov_b32 v3, 1
    s_mov_b64 exec, 1
    ds_add_rtn_u32 v4, v2, v3
    s_waitcnt lgkmcnt(0)
    v_readfirstlane_b32 s60, v4
    s_mov_b64 exec, -1
    s_cmp_lg_u32 s60, 11
    s_cbranch_scc1 K1_EX
    s_waitcnt lgkmcnt(0)
    s_mul_i32 s80, s80, 0x9e3779b1
    s_add_u32 s80, s80, 0x7f4a7c15
    v_mov_b32 v30, v31
    v_mov_b32 v31, s80
    s_lshl_b32 s56, s44, 3
    s_add_u32 s56, s56, 0x18a0000
    buffer_store_dwordx2 v[30:31], v29, s[36:39], s56 offen sc1
    ds_write_b32 v2, v31 offset:16
    s_waitcnt lgkmcnt(0)
K1_EX:
    s_barrier
    s_branch K2_START
K1_PF:
    s_and_b32 s40, s2, 7
    s_lshr_b32 s41, s2, 3
    s_sub_u32 s41, s41, 26
    s_lshl_b32 s41, s41, 2
    s_add_u32 s41, s41, s3
    s_cmp_eq_u32 s40, 0
    s_cselect_b32 s42, 20, 24
    s_cselect_b32 s43, 16, 12
    s_mov_b32 s46, 8193
    s_cselect_b32 s46, 10923, s46
    s_mov_b32 s47, 720896
    s_cselect_b32 s47, 737280, s47
    s_mov_b32 s48, 208
    s_cselect_b32 s48, 156, s48
    s_sub_u32 s41, s41, s43
    v_and_b32 v3, 15, v2
    v_cmp_le_u32 vcc, 4, v3
    v_lshlrev_b32 v3, 7, v2
    v_mov_b32 v4, 0x80000000
    v_cndmask_b32 v3, v4, v3, vcc
    s_mul_i32 s40, s40, 98304
    s_waitcnt lgkmcnt(0)
    s_mov_b32 s24, s4
    s_mov_b32 s25, s5
    s_mov_b32 s26, 0x1388000
    s_mov_b32 s27, 0x20000
    s_barrier
K1_PFL:
    s_mul_i32 s44, s41, s46
    s_lshr_b32 s44, s44, 16
    s_mul_i32 s44, s44, s47
    s_lshl_b32 s45, s41, 13
    s_add_u32 s44, s44, s45
    s_add_u32 s44, s44, s40
    buffer_load_dword v5, v3, s[24:27], s44 offen
    s_waitcnt vmcnt(8)
    s_add_u32 s41, s41, s42
    s_cmp_lt_u32 s41, s48
    s_cbranch_scc1 K1_PFL
    s_waitcnt vmcnt(0)
    s_barrier
K2_START:
    s_load_dwordx2 s[14:15], s[0:1], 80
    s_load_dwordx2 s[4:5], s[0:1], 0
    s_load_dwordx4 s[8:11], s[0:1], 64
    v_mbcnt_lo_u32_b32 v0, -1, 0
    v_mbcnt_hi_u32_b32 v0, -1, v0
    s_bfe_u32 s40, s2, 0x20001
    s_lshr_b32 s41, s2, 3
    s_lshl_b32 s41, s41, 1
    s_and_b32 s60, s2, 1
    s_or_b32 s41, s41, s60
    v_and_b32 v1, 15, v0
    v_lshrrev_b32 v2, 4, v0
    v_mov_b32 v3, 0xffff0000
    v_lshlrev_b32 v21, 3, v2
    v_add_u32 v21, 50176, v21
    s_mul_i32 s59, s2, 163840
    s_add_u32 s59, s59, 0x9800000
    s_mov_b32 s48, 0
    s_mov_b32 s49, 64
    s_mov_b32 s50, 1
    s_mov_b32 s51, 0
    s_mov_b32 s44, 0
    s_mov_b32 s45, 262144
    s_waitcnt lgkmcnt(0)
    s_mov_b32 s24, s14
    s_mov_b32 s25, s15
    s_mov_b32 s26, 0x10000000
    s_mov_b32 s27, 0x20000
    s_mov_b32 s28, s4
    s_mov_b32 s29, s5
    s_mov_b32 s30, 0x1388000
    s_mov_b32 s31, 0x20000
    s_mov_b32 s32, s8
    s_mov_b32 s33, s9
    s_mov_b32 s34, 0x1388000
    s_mov_b32 s35, 0x20000
K2_ROUND:
    v_mov_b32 v30, v0
    v_mov_b32 v31, 1
    v_mov_b32 v32, 0x80000000
    v_mov_b32 v8, 0
    v_mov_b32 v9, 0
    v_mov_b32 v10, 0
    v_mov_b32 v11, 0
    s_cmp_ge_u32 s3, 12
    s_cbranch_scc1 K2_RECW
    s_cmp_eq_u32 s50, 0
    s_cbranch_scc1 K2_JOIN
    s_cmp_ge_u32 s3, 8
    s_cbranch_scc1 K2_LOADER
    s_cmp_lg_u32 s3, 0
    s_cbranch_scc1 K2_JOIN
    v_mov_b32 v12, 162816
    ds_read_b32 v13, v12 offset:16
    s_waitcnt lgkmcnt(0)
    s_cmp_lt_u32 s2, 255
    s_cbranch_scc1 K2_GW
    v_lshlrev_b32 v12, 5, v0
    v_min_u32 v14, 512, v12
K2_GP:
    s_mov_b32 s60, 0x18b0000
    buffer_load_dword v16, v12, s[24:27], s60 offen sc1
    s_mov_b32 s60, 0x18b0800
    buffer_load_dword v17, v12, s[24:27], s60 offen sc1
    s_mov_b32 s60, 0x18b1000
    buffer_load_dword v18, v12, s[24:27], s60 offen sc1
    s_mov_b32 s60, 0x18b1800
    buffer_load_dword v19, v14, s[24:27], s60 offen sc1
    s_waitcnt vmcnt(0)
    v_xor_b32 v16, v13, v16
    v_xor_b32 v17, v13, v17
    v_xor_b32 v18, v13, v18
    v_xor_b32 v19, v13, v19
    v_or3_b32 v16, v16, v17, v18
    v_or_b32 v16, v16, v19
    v_cmp_ne_u32 vcc, 0, v16
    s_cbranch_vccz K2_GP_D
    s_sleep 4
    s_sub_u32 s45, s45, 1
    s_cbranch_scc0 K2_GP
K2_GP_D:
    v_lshlrev_b32 v12, 7, v0
    s_and_b32 s60, s2, 0
    s_mul_i32 s60, s60, 32768
    s_add_u32 s60, s60, 0x18b8000
    buffer_store_dword v13, v12, s[24:27], s60 offen sc1
    s_add_u32 s60, s60, 8192
    buffer_store_dword v13, v12, s[24:27], s60 offen sc1
    s_add_u32 s60, s60, 8192
    buffer_store_dword v13, v12, s[24:27], s60 offen sc1
    s_add_u32 s60, s60, 8192
    buffer_store_dword v13, v12, s[24:27], s60 offen sc1
    s_add_u32 s60, s60, 8192
    s_mov_b64 exec, -1
    s_branch K2_JOIN
K2_GW:
    s_lshl_b32 s60, s2, 7
    s_add_u32 s60, s60, 0x18b8000
    s_mov_b64 exec, 1
K2_GQ:
    buffer_load_dword v4, v8, s[24:27], s60 offen sc1
    s_waitcnt vmcnt(0)
    v_cmp_eq_u32 vcc, v13, v4
    s_cbranch_vccnz K2_GQ_D
    s_sleep 4
    s_sub_u32 s45, s45, 1
    s_cbranch_scc0 K2_GQ
K2_GQ_D:
    s_mov_b64 exec, -1
    s_branch K2_JOIN
K2_RECW:
    s_sub_u32 s63, s3, 12
    s_lshl_b32 s60, s63, 10
    v_lshlrev_b32 v5, 4, v0
    v_add_u32 v5, s60, v5
    ds_write_b128 v5, v[8:11] offset:0
    ds_write_b128 v5, v[8:11] offset:4096
    ds_write_b128 v5, v[8:11] offset:8192
    ds_write_b128 v5, v[8:11] offset:12288
    ds_write_b128 v5, v[8:11] offset:16384
    ds_write_b128 v5, v[8:11] offset:20480
    ds_write_b128 v5, v[8:11] offset:24576
    ds_write_b128 v5, v[8:11] offset:28672
    ds_write_b128 v5, v[8:11] offset:32768
    ds_write_b128 v5, v[8:11] offset:36864
    s_cmp_eq_u32 s63, 3
    s_cbranch_scc1 K2_ZD
    ds_write_b128 v5, v[8:11] offset:40960
K2_ZD:
    v_mov_b32 v12, 162816
    s_add_u32 s44, s44, 4
    ds_read_b32 v15, v12 offset:16
    s_lshl_b32 s60, s41, 9
    s_mul_i32 s61, s63, 96
    s_add_u32 s60, s60, s61
    s_add_u32 s60, s60, 0x18a0000
    s_cmp_eq_u32 s63, 3
    s_movk_i32 s62, 0xfff
    s_cselect_b32 s62, 0x7ff, s62
    v_lshlrev_b32 v5, 3, v0
    v_mov_b32 v6, 0
    s_mov_b32 exec_lo, s62
    s_mov_b32 exec_hi, 0
K2_RP:
    buffer_load_dwordx2 v[6:7], v5, s[24:27], s60 offen sc1
    s_waitcnt vmcnt(0) lgkmcnt(0)
    v_cmp_ne_u32 vcc, v15, v7
    s_cbranch_vccz K2_RP_D
    s_sleep 4
    s_sub_u32 s45, s45, 1
    s_cbranch_scc0 K2_RP
    s_mov_b32 s45, 0
    v_mov_b32 v6, 0
K2_RP_D:
    s_mov_b64 exec, 1
    ds_add_u32 v12, v31 offset:4
    s_mov_b64 exec, -1
    v_mov_b32 v13, v6
    v_mul_u32_u24 v14, 12, v0
    s_mul_i32 s62, s63, 768
    s_add_u32 s62, s62, s41
    s_mul_i32 s62, s62, 41088
    s_mul_i32 s61, s48, 12
    s_add_u32 s62, s62, s61
    s_add_u32 s62, s62, 0x18c0000
    v_subrev_u32 v6, s48, v13
    v_min_i32 v6, s49, v6
    s_nop 0
    v_readlane_b32 s64, v6, 0
    v_readlane_b32 s65, v6, 1
    v_readlane_b32 s66, v6, 2
    v_readlane_b32 s67, v6, 3
    v_readlane_b32 s68, v6, 4
    v_readlane_b32 s69, v6, 5
    v_readlane_b32 s70, v6, 6
    v_readlane_b32 s71, v6, 7
    v_readlane_b32 s72, v6, 8
    v_readlane_b32 s73, v6, 9
    v_readlane_b32 s74, v6, 10
    v_readlane_b32 s75, v6, 11
    v_cmp_gt_i32 vcc, s64, v0
    s_nop 1
    v_cndmask_b32 v5, v32, v14, vcc
    buffer_load_dwordx3 v[80:82], v5, s[24:27], s62 offen sc1
    v_cmp_gt_i32 vcc, s65, v0
    s_add_u32 s62, s62, 2629632
    s_nop 0
    v_cndmask_b32 v5, v32, v14, vcc
    buffer_load_dwordx3 v[84:86], v5, s[24:27], s62 offen sc1
    v_cmp_gt_i32 vcc, s66, v0
    s_add_u32 s62, s62, 2629632
    s_nop 0
    v_cndmask_b32 v5, v32, v14, vcc
    buffer_load_dwordx3 v[88:90], v5, s[24:27], s62 offen sc1
    v_cmp_gt_i32 vcc, s67, v0
    s_add_u32 s62, s62, 2629632
    s_nop 0
    v_cndmask_b32 v5, v32, v14, vcc
    buffer_load_dwordx3 v[92:94], v5, s[24:27], s62 offen sc1
    v_cmp_gt_i32 vcc, s68, v0
    s_add_u32 s62, s62, 2629632
    s_nop 0
    v_cndmask_b32 v5, v32, v14, vcc
    buffer_load_dwordx3 v[96:98], v5, s[24:27], s62 offen sc1
    v_cmp_gt_i32 vcc, s69, v0
    s_add_u32 s62, s62, 2629632
    s_nop 0
    v_cndmask_b32 v5, v32, v14, vcc
    buffer_load_dwordx3 v[100:102], v5, s[24:27], s62 offen sc1
    v_cmp_gt_i32 vcc, s70, v0
    s_add_u32 s62, s62, 2629632
    s_nop 0
    v_cndmask_b32 v5, v32, v14, vcc
    buffer_load_dwordx3 v[104:106], v5, s[24:27], s62 offen sc1
    v_cmp_gt_i32 vcc, s71, v0
    s_add_u32 s62, s62, 2629632
    s_nop 0
    v_cndmask_b32 v5, v32, v14, vcc
    buffer_load_dwordx3 v[108:110], v5, s[24:27], s62 offen sc1
    v_cmp_gt_i32 vcc, s72, v0
    s_add_u32 s62, s62, 2629632
    s_nop 0
    v_cndmask_b32 v5, v32, v14, vcc
    buffer_load_dwordx3 v[112:114], v5, s[24:27], s62 offen sc1
    v_cmp_gt_i32 vcc, s73, v0
    s_add_u32 s62, s62, 2629632
    s_nop 0
    v_cndmask_b32 v5, v32, v14, vcc
    buffer_load_dwordx3 v[116:118], v5, s[24:27], s62 offen sc1
    v_cmp_gt_i32 vcc, s74, v0
    s_add_u32 s62, s62, 2629632
    s_nop 0
    v_cndmask_b32 v5, v32, v14, vcc
    buffer_load_dwordx3 v[120:122], v5, s[24:27], s62 offen sc1
    v_cmp_gt_i32 vcc, s75, v0
    s_add_u32 s62, s62, 2629632
    s_nop 0
    v_cndmask_b32 v5, v32, v14, vcc
    buffer_load_dwordx3 v[124:126], v5, s[24:27], s62 offen sc1
K2_ZW:
    ds_read_b32 v5, v12 offset:4
    s_waitcnt lgkmcnt(0)
    v_cmp_gt_u32 vcc, s44, v5
    s_cbranch_vccnz K2_ZW
    ds_max_u32 v8, v13 offset:3008
    v_mov_b32 v6, 0
    s_waitcnt vmcnt(11)
    v_cmp_ne_u32 vcc, 0, v81
    v_lshrrev_b32 v5, 14, v82
    v_max_u32 v6, v6, v81
    s_mov_b64 exec, vcc
    ds_add_rtn_u32 v83, v5, v31 offset:0
    s_mov_b64 exec, -1
    s_waitcnt vmcnt(10)
    v_cmp_ne_u32 vcc, 0, v85
    v_lshrrev_b32 v5, 14, v86
    v_max_u32 v6, v6, v85
    s_mov_b64 exec, vcc
    ds_add_rtn_u32 v87, v5, v31 offset:0
    s_mov_b64 exec, -1
    s_waitcnt vmcnt(9)
    v_cmp_ne_u32 vcc, 0, v89
    v_lshrrev_b32 v5, 14, v90
    v_max_u32 v6, v6, v89
    s_mov_b64 exec, vcc
    ds_add_rtn_u32 v91, v5, v31 offset:0
    s_mov_b64 exec, -1
    s_waitcnt vmcnt(8)
    v_cmp_ne_u32 vcc, 0, v93
    v_lshrrev_b32 v5, 14, v94
    v_max_u32 v6, v6, v93
    s_mov_b64 exec, vcc
    ds_add_rtn_u32 v95, v5, v31 offset:0
    s_mov_b64 exec, -1
    s_waitcnt vmcnt(7)
    v_cmp_ne_u32 vcc, 0, v97
    v_lshrrev_b32 v5, 14, v98
    v_max_u32 v6, v6, v97
    s_mov_b64 exec, vcc
    ds_add_rtn_u32 v99, v5, v31 offset:0
    s_mov_b64 exec, -1
    s_waitcnt vmcnt(6)
    v_cmp_ne_u32 vcc, 0, v101
    v_lshrrev_b32 v5, 14, v102
    v_max_u32 v6, v6, v101
    s_mov_b64 exec, vcc
    ds_add_rtn_u32 v103, v5, v31 offset:0
    s_mov_b64 exec, -1
    s_waitcnt vmcnt(5)
    v_cmp_ne_u32 vcc, 0, v105
    v_lshrrev_b32 v5, 14, v106
    v_max_u32 v6, v6, v105
    s_mov_b64 exec, vcc
    ds_add_rtn_u32 v107, v5, v31 offset:0
    s_mov_b64 exec, -1
    s_waitcnt vmcnt(4)
    v_cmp_ne_u32 vcc, 0, v109
    v_lshrrev_b32 v5, 14, v110
    v_max_u32 v6, v6, v109
    s_mov_b64 exec, vcc
    ds_add_rtn_u32 v111, v5, v31 offset:0
    s_mov_b64 exec, -1
    s_waitcnt vmcnt(3)
    v_cmp_ne_u32 vcc, 0, v113
    v_lshrrev_b32 v5, 14, v114
    v_max_u32 v6, v6, v113
    s_mov_b64 exec, vcc
    ds_add_rtn_u32 v115, v5, v31 offset:0
    s_mov_b64 exec, -1
    s_waitcnt vmcnt(2)
    v_cmp_ne_u32 vcc, 0, v117
    v_lshrrev_b32 v5, 14, v118
    v_max_u32 v6, v6, v117
    s_mov_b64 exec, vcc
    ds_add_rtn_u32 v119, v5, v31 offset:0
    s_mov_b64 exec, -1
    s_waitcnt vmcnt(1)
    v_cmp_ne_u32 vcc, 0, v121
    v_lshrrev_b32 v5, 14, v122
    v_max_u32 v6, v6, v121
    s_mov_b64 exec, vcc
    ds_add_rtn_u32 v123, v5, v31 offset:0
    s_mov_b64 exec, -1
    s_waitcnt vmcnt(0)
    v_cmp_ne_u32 vcc, 0, v125
    v_lshrrev_b32 v5, 14, v126
    v_max_u32 v6, v6, v125
    s_mov_b64 exec, vcc
    ds_add_rtn_u32 v127, v5, v31 offset:0
    s_mov_b64 exec, -1
    v_cmp_le_u32 vcc, 0x78000000, v6
    s_cbranch_vccz K2_NSL
    ds_write_b32 v8, v31 offset:3016
K2_NSL:
    s_waitcnt lgkmcnt(0)
    s_mov_b64 exec, 1
    ds_add_u32 v8, v31 offset:3020
    s_mov_b64 exec, -1
    s_cmp_lg_u32 s3, 12
    s_cbranch_scc1 K2_WAIT2
    s_setprio 3
    v_lshlrev_b32 v16, 2, v30
K2_WAIT1:
    ds_read_b32 v17, v8 offset:3020
    s_waitcnt lgkmcnt(0)
    v_cmp_ne_u32 vcc, 4, v17
    s_cbranch_vccnz K2_WAIT1
    ds_read_b32 v34, v16 offset:0
    ds_read_b32 v35, v16 offset:256
    ds_read_b32 v36, v16 offset:512
    s_waitcnt lgkmcnt(0)
    v_min_u32 v37, 63, v34
    v_sub_u32 v37, 63, v37
    v_lshlrev_b32 v37, 2, v37
    ds_add_rtn_u32 v40, v37, v31 offset:768
    v_min_u32 v38, 63, v35
    v_sub_u32 v38, 63, v38
    v_lshlrev_b32 v38, 2, v38
    ds_add_rtn_u32 v41, v38, v31 offset:768
    v_min_u32 v39, 63, v36
    v_sub_u32 v39, 63, v39
    v_lshlrev_b32 v39, 2, v39
    s_mov_b32 exec_hi, 0
    ds_add_rtn_u32 v42, v39, v31 offset:768
    s_mov_b32 exec_hi, -1
    ds_read_b32 v18, v16 offset:768
    v_max_u32 v34, 1, v34
    v_max_u32 v35, 1, v35
    v_max_u32 v36, 1, v36
    s_waitcnt lgkmcnt(0)
    v_mov_b32 v19, v18
    s_nop 1
    v_add_u32_dpp v19, v19, v19 row_shr:1 row_mask:0xf bank_mask:0xf bound_ctrl:0
    s_nop 1
    v_add_u32_dpp v19, v19, v19 row_shr:2 row_mask:0xf bank_mask:0xf bound_ctrl:0
    s_nop 1
    v_add_u32_dpp v19, v19, v19 row_shr:4 row_mask:0xf bank_mask:0xf bound_ctrl:0
    s_nop 1
    v_add_u32_dpp v19, v19, v19 row_shr:8 row_mask:0xf bank_mask:0xf bound_ctrl:0
    s_nop 1
    v_add_u32_dpp v19, v19, v19 row_bcast:15 row_mask:0xa bank_mask:0xf
    s_nop 1
    v_add_u32_dpp v19, v19, v19 row_bcast:31 row_mask:0xc bank_mask:0xf
    v_sub_u32 v19, v19, v18
    ds_bpermute_b32 v37, v37, v19
    ds_bpermute_b32 v38, v38, v19
    ds_bpermute_b32 v39, v39, v19
    s_mov_b32 s60, 0x43120
    s_mov_b32 s61, 0x77070
    s_waitcnt lgkmcnt(0)
    v_add_u32 v37, v37, v40
    v_and_b32 v43, 3, v37
    v_lshrrev_b32 v17, 3, v37
    v_and_b32 v17, 28, v17
    v_lshrrev_b32 v37, 2, v37
    v_lshrrev_b32 v18, v17, s61
    v_xor_b32 v37, v37, v18
    v_and_b32 v49, 7, v37
    v_bfe_u32 v46, s60, v17, 3
    v_lshl_add_u32 v37, v49, 3, v46
    v_lshlrev_b32 v37, 2, v37
    v_add_lshl_u32 v18, v37, v43, 2
    v_add_u32 v17, 0, v30
    ds_max_u32 v37, v34 offset:1024
    ds_write_b32 v18, v17 offset:1280
    v_add_u32 v38, v38, v41
    v_and_b32 v44, 3, v38
    v_lshrrev_b32 v17, 3, v38
    v_and_b32 v17, 28, v17
    v_lshrrev_b32 v38, 2, v38
    v_lshrrev_b32 v18, v17, s61
    v_xor_b32 v38, v38, v18
    v_and_b32 v50, 7, v38
    v_bfe_u32 v47, s60, v17, 3
    v_lshl_add_u32 v38, v50, 3, v47
    v_lshlrev_b32 v38, 2, v38
    v_add_lshl_u32 v18, v38, v44, 2
    v_add_u32 v17, 64, v30
    ds_max_u32 v38, v35 offset:1024
    ds_write_b32 v18, v17 offset:1280
    v_add_u32 v39, v39, v42
    v_and_b32 v45, 3, v39
    v_lshrrev_b32 v17, 3, v39
    v_and_b32 v17, 28, v17
    v_lshrrev_b32 v39, 2, v39
    v_lshrrev_b32 v18, v17, s61
    v_xor_b32 v39, v39, v18
    v_and_b32 v51, 7, v39
    v_bfe_u32 v48, s60, v17, 3
    v_lshl_add_u32 v39, v51, 3, v48
    v_lshlrev_b32 v39, 2, v39
    v_add_lshl_u32 v18, v39, v45, 2
    v_add_u32 v17, 128, v30
    s_mov_b32 exec_hi, 0
    ds_max_u32 v39, v36 offset:1024
    ds_write_b32 v18, v17 offset:1280
    s_mov_b32 exec_hi, -1
    v_lshlrev_b32 v37, 5, v49
    ds_read_b128 v[52:55], v37 offset:1024
    v_lshlrev_b32 v38, 5, v50
    ds_read_b128 v[58:61], v38 offset:1024
    v_lshlrev_b32 v39, 5, v51
    ds_read_b128 v[64:67], v39 offset:1024
    v_lshlrev_b32 v17, 5, v30
    v_and_b32 v17, 0xe0, v17
    ds_read_b128 v[70:73], v17 offset:1024
    ds_read_b32 v74, v17 offset:1040
    v_mul_u32_u24 v49, 104, v49
    v_lshl_or_b32 v49, v43, 16, v49
    v_mul_u32_u24 v50, 104, v50
    v_lshl_or_b32 v50, v44, 16, v50
    v_mul_u32_u24 v51, 104, v51
    v_lshl_or_b32 v51, v45, 16, v51
    s_waitcnt lgkmcnt(0)
    v_cmp_lt_u32 vcc, 0, v46
    v_mov_b32 v53, 52
    s_nop 0
    v_cndmask_b32 v19, 0, v52, vcc
    v_cmp_lt_u32 vcc, 1, v46
    v_add_u32 v54, v53, v54
    v_add_u32 v55, v54, v55
    v_cndmask_b32 v19, v19, v53, vcc
    v_cmp_lt_u32 vcc, 2, v46
    v_cmp_lt_u32 s[62:63], 3, v46
    s_nop 0
    v_cndmask_b32 v19, v19, v54, vcc
    v_cndmask_b32 v19, v19, v55, s[62:63]
    v_add_u32 v52, v49, v19
    ds_write_b32 v16, v52 offset:2304
    v_cmp_lt_u32 vcc, 0, v47
    v_mov_b32 v59, 52
    s_nop 0
    v_cndmask_b32 v19, 0, v58, vcc
    v_cmp_lt_u32 vcc, 1, v47
    v_add_u32 v60, v59, v60
    v_add_u32 v61, v60, v61
    v_cndmask_b32 v19, v19, v59, vcc
    v_cmp_lt_u32 vcc, 2, v47
    v_cmp_lt_u32 s[62:63], 3, v47
    s_nop 0
    v_cndmask_b32 v19, v19, v60, vcc
    v_cndmask_b32 v19, v19, v61, s[62:63]
    v_add_u32 v58, v50, v19
    ds_write_b32 v16, v58 offset:2560
    v_cmp_lt_u32 vcc, 0, v48
    v_mov_b32 v65, 52
    s_nop 0
    v_cndmask_b32 v19, 0, v64, vcc
    v_cmp_lt_u32 vcc, 1, v48
    v_add_u32 v66, v65, v66
    v_add_u32 v67, v66, v67
    v_cndmask_b32 v19, v19, v65, vcc
    v_cmp_lt_u32 vcc, 2, v48
    v_cmp_lt_u32 s[62:63], 3, v48
    s_nop 0
    v_cndmask_b32 v19, v19, v66, vcc
    v_cndmask_b32 v19, v19, v67, s[62:63]
    v_add_u32 v64, v51, v19
    s_mov_b32 exec_hi, 0
    ds_write_b32 v16, v64 offset:2816
    s_mov_b32 exec_hi, -1
    v_add_u32 v70, v70, v71
    v_add3_u32 v72, v72, v73, v74
    v_add_u32 v72, 0, v72
    v_max_u32 v70, v70, v72
    v_cmp_lt_u32 vcc, 52, v70
    s_cmp_lg_u64 vcc, 0
    s_cselect_b32 s60, 2, 1
    v_mov_b32 v17, s60
    s_waitcnt lgkmcnt(0)
    ds_write_b32 v8, v17 offset:3024
    s_setprio 0
K2_WAIT2:
    ds_read_b32 v17, v8 offset:3024
    s_waitcnt lgkmcnt(0)
    v_cmp_ne_u32 vcc, 0, v17
    s_cbranch_vccnz K2_RDY
    s_sleep 1
    s_branch K2_WAIT2
K2_RDY:
    v_cmp_ne_u32 vcc, 1, v17
    s_cbranch_vccnz K2_JOIN
    v_lshrrev_b32 v34, 14, v82
    ds_read_b32 v34, v34 offset:2304
    v_lshrrev_b32 v35, 14, v86
    ds_read_b32 v35, v35 offset:2304
    v_lshrrev_b32 v36, 14, v90
    ds_read_b32 v36, v36 offset:2304
    v_lshrrev_b32 v37, 14, v94
    ds_read_b32 v37, v37 offset:2304
    v_lshrrev_b32 v38, 14, v98
    ds_read_b32 v38, v38 offset:2304
    v_lshrrev_b32 v39, 14, v102
    ds_read_b32 v39, v39 offset:2304
    v_lshrrev_b32 v40, 14, v106
    ds_read_b32 v40, v40 offset:2304
    v_lshrrev_b32 v41, 14, v110
    ds_read_b32 v41, v41 offset:2304
    v_lshrrev_b32 v42, 14, v114
    ds_read_b32 v42, v42 offset:2304
    v_lshrrev_b32 v43, 14, v118
    ds_read_b32 v43, v43 offset:2304
    v_lshrrev_b32 v44, 14, v122
    ds_read_b32 v44, v44 offset:2304
    v_lshrrev_b32 v45, 14, v126
    ds_read_b32 v45, v45 offset:2304
    v_and_b32 v82, 0xffff, v82
    v_lshl_or_b32 v82, v82, 8, v32
    v_and_b32 v86, 0xffff, v86
    v_lshl_or_b32 v86, v86, 8, v32
    v_and_b32 v90, 0xffff, v90
    v_lshl_or_b32 v90, v90, 8, v32
    v_and_b32 v94, 0xffff, v94
    v_lshl_or_b32 v94, v94, 8, v32
    v_and_b32 v98, 0xffff, v98
    v_lshl_or_b32 v98, v98, 8, v32
    v_and_b32 v102, 0xffff, v102
    v_lshl_or_b32 v102, v102, 8, v32
    v_and_b32 v106, 0xffff, v106
    v_lshl_or_b32 v106, v106, 8, v32
    v_and_b32 v110, 0xffff, v110
    v_lshl_or_b32 v110, v110, 8, v32
    v_and_b32 v114, 0xffff, v114
    v_lshl_or_b32 v114, v114, 8, v32
    v_and_b32 v118, 0xffff, v118
    v_lshl_or_b32 v118, v118, 8, v32
    v_and_b32 v122, 0xffff, v122
    v_lshl_or_b32 v122, v122, 8, v32
    v_and_b32 v126, 0xffff, v126
    v_lshl_or_b32 v126, v126, 8, v32
    s_waitcnt lgkmcnt(0)
    v_cmp_ne_u32 vcc, 0, v81
    v_add_u32 v34, v34, v83
    v_bfe_u32 v16, v34, 2, 14
    v_and_b32 v17, 3, v34
    v_lshrrev_b32 v34, 14, v34
    v_or_b32 v17, v17, v34
    v_mul_u32_u24 v16, 192, v16
    v_lshl_add_u32 v34, v17, 2, v16
    v_lshl_add_u32 v83, v17, 3, v16
    s_mov_b64 exec, vcc
    ds_write_b32 v34, v82 offset:3072
    ds_write_b64 v83, v[80:81] offset:3136
    s_mov_b64 exec, -1
    v_cmp_ne_u32 vcc, 0, v85
    v_add_u32 v35, v35, v87
    v_bfe_u32 v16, v35, 2, 14
    v_and_b32 v17, 3, v35
    v_lshrrev_b32 v35, 14, v35
    v_or_b32 v17, v17, v35
    v_mul_u32_u24 v16, 192, v16
    v_lshl_add_u32 v35, v17, 2, v16
    v_lshl_add_u32 v87, v17, 3, v16
    s_mov_b64 exec, vcc
    ds_write_b32 v35, v86 offset:3072
    ds_write_b64 v87, v[84:85] offset:3136
    s_mov_b64 exec, -1
    v_cmp_ne_u32 vcc, 0, v89
    v_add_u32 v36, v36, v91
    v_bfe_u32 v16, v36, 2, 14
    v_and_b32 v17, 3, v36
    v_lshrrev_b32 v36, 14, v36
    v_or_b32 v17, v17, v36
    v_mul_u32_u24 v16, 192, v16
    v_lshl_add_u32 v36, v17, 2, v16
    v_lshl_add_u32 v91, v17, 3, v16
    s_mov_b64 exec, vcc
    ds_write_b32 v36, v90 offset:3072
    ds_write_b64 v91, v[88:89] offset:3136
    s_mov_b64 exec, -1
    v_cmp_ne_u32 vcc, 0, v93
    v_add_u32 v37, v37, v95
    v_bfe_u32 v16, v37, 2, 14
    v_and_b32 v17, 3, v37
    v_lshrrev_b32 v37, 14, v37
    v_or_b32 v17, v17, v37
    v_mul_u32_u24 v16, 192, v16
    v_lshl_add_u32 v37, v17, 2, v16
    v_lshl_add_u32 v95, v17, 3, v16
    s_mov_b64 exec, vcc
    ds_write_b32 v37, v94 offset:3072
    ds_write_b64 v95, v[92:93] offset:3136
    s_mov_b64 exec, -1
    v_cmp_ne_u32 vcc, 0, v97
    v_add_u32 v38, v38, v99
    v_bfe_u32 v16, v38, 2, 14
    v_and_b32 v17, 3, v38
    v_lshrrev_b32 v38, 14, v38
    v_or_b32 v17, v17, v38
    v_mul_u32_u24 v16, 192, v16
    v_lshl_add_u32 v38, v17, 2, v16
    v_lshl_add_u32 v99, v17, 3, v16
    s_mov_b64 exec, vcc
    ds_write_b32 v38, v98 offset:3072
    ds_write_b64 v99, v[96:97] offset:3136
    s_mov_b64 exec, -1
    v_cmp_ne_u32 vcc, 0, v101
    v_add_u32 v39, v39, v103
    v_bfe_u32 v16, v39, 2, 14
    v_and_b32 v17, 3, v39
    v_lshrrev_b32 v39, 14, v39
    v_or_b32 v17, v17, v39
    v_mul_u32_u24 v16, 192, v16
    v_lshl_add_u32 v39, v17, 2, v16
    v_lshl_add_u32 v103, v17, 3, v16
    s_mov_b64 exec, vcc
    ds_write_b32 v39, v102 offset:3072
    ds_write_b64 v103, v[100:101] offset:3136
    s_mov_b64 exec, -1
    v_cmp_ne_u32 vcc, 0, v105
    v_add_u32 v40, v40, v107
    v_bfe_u32 v16, v40, 2, 14
    v_and_b32 v17, 3, v40
    v_lshrrev_b32 v40, 14, v40
    v_or_b32 v17, v17, v40
    v_mul_u32_u24 v16, 192, v16
    v_lshl_add_u32 v40, v17, 2, v16
    v_lshl_add_u32 v107, v17, 3, v16
    s_mov_b64 exec, vcc
    ds_write_b32 v40, v106 offset:3072
    ds_write_b64 v107, v[104:105] offset:3136
    s_mov_b64 exec, -1
    v_cmp_ne_u32 vcc, 0, v109
    v_add_u32 v41, v41, v111
    v_bfe_u32 v16, v41, 2, 14
    v_and_b32 v17, 3, v41
    v_lshrrev_b32 v41, 14, v41
    v_or_b32 v17, v17, v41
    v_mul_u32_u24 v16, 192, v16
    v_lshl_add_u32 v41, v17, 2, v16
    v_lshl_add_u32 v111, v17, 3, v16
    s_mov_b64 exec, vcc
    ds_write_b32 v41, v110 offset:3072
    ds_write_b64 v111, v[108:109] offset:3136
    s_mov_b64 exec, -1
    v_cmp_ne_u32 vcc, 0, v113
    v_add_u32 v42, v42, v115
    v_bfe_u32 v16, v42, 2, 14
    v_and_b32 v17, 3, v42
    v_lshrrev_b32 v42, 14, v42
    v_or_b32 v17, v17, v42
    v_mul_u32_u24 v16, 192, v16
    v_lshl_add_u32 v42, v17, 2, v16
    v_lshl_add_u32 v115, v17, 3, v16
    s_mov_b64 exec, vcc
    ds_write_b32 v42, v114 offset:3072
    ds_write_b64 v115, v[112:113] offset:3136
    s_mov_b64 exec, -1
    v_cmp_ne_u32 vcc, 0, v117
    v_add_u32 v43, v43, v119
    v_bfe_u32 v16, v43, 2, 14
    v_and_b32 v17, 3, v43
    v_lshrrev_b32 v43, 14, v43
    v_or_b32 v17, v17, v43
    v_mul_u32_u24 v16, 192, v16
    v_lshl_add_u32 v43, v17, 2, v16
    v_lshl_add_u32 v119, v17, 3, v16
    s_mov_b64 exec, vcc
    ds_write_b32 v43, v118 offset:3072
    ds_write_b64 v119, v[116:117] offset:3136
    s_mov_b64 exec, -1
    v_cmp_ne_u32 vcc, 0, v121
    v_add_u32 v44, v44, v123
    v_bfe_u32 v16, v44, 2, 14
    v_and_b32 v17, 3, v44
    v_lshrrev_b32 v44, 14, v44
    v_or_b32 v17, v17, v44
    v_mul_u32_u24 v16, 192, v16
    v_lshl_add_u32 v44, v17, 2, v16
    v_lshl_add_u32 v123, v17, 3, v16
    s_mov_b64 exec, vcc
    ds_write_b32 v44, v122 offset:3072
    ds_write_b64 v123, v[120:121] offset:3136
    s_mov_b64 exec, -1
    v_cmp_ne_u32 vcc, 0, v125
    v_add_u32 v45, v45, v127
    v_bfe_u32 v16, v45, 2, 14
    v_and_b32 v17, 3, v45
    v_lshrrev_b32 v45, 14, v45
    v_or_b32 v17, v17, v45
    v_mul_u32_u24 v16, 192, v16
    v_lshl_add_u32 v45, v17, 2, v16
    v_lshl_add_u32 v127, v17, 3, v16
    s_mov_b64 exec, vcc
    ds_write_b32 v45, v126 offset:3072
    ds_write_b64 v127, v[124:125] offset:3136
    s_mov_b64 exec, -1
    s_branch K2_JOIN
K2_LOADER:
    v_lshrrev_b32 v4, 5, v30
    v_lshlrev_b32 v4, 17, v4
    v_bfe_u32 v5, v30, 3, 2
    v_lshl_add_u32 v4, v5, 9, v4
    v_and_b32 v5, 7, v30
    v_lshl_add_u32 v4, v5, 4, v4
    v_lshlrev_b32 v5, 4, v30
    s_sub_u32 s63, s3, 8
    v_mov_b32 v6, 162816
K2_LW0:
    ds_read_b32 v7, v6 offset:0
    s_waitcnt lgkmcnt(0)
    v_cmp_gt_u32 vcc, 9, v7
    s_cbranch_vccz K2_LW0_D
    s_sleep 2
    s_branch K2_LW0
K2_LW0_D:
    s_lshl_b32 s60, s41, 11
    s_lshl_b32 s61, s40, 7
    s_add_u32 s60, s60, s61
    s_lshl_b32 s61, s63, 18
    s_add_u32 s60, s60, s61
    s_lshl_b32 s61, s63, 10
    s_add_u32 s61, s61, 80896
    s_mov_b32 s62, 20
    s_cmp_ge_u32 s2, 209
    s_cbranch_scc1 K2_RL
    s_mov_b32 s62, 14
    s_add_u32 s60, s60, 6291456
    s_add_u32 s61, s61, 24576
K2_RL:
    s_mov_b32 m0, s61
    s_add_u32 s61, s61, 4096
    buffer_load_dwordx4 v4, s[28:31], s60 offen  lds
    s_add_u32 s60, s60, 0x100000
    s_sub_u32 s62, s62, 1
    s_cmp_lg_u32 s62, 0
    s_cbranch_scc1 K2_RL
K2_LW:
    ds_read_b32 v7, v6 offset:4
    s_waitcnt lgkmcnt(0)
    v_cmp_gt_u32 vcc, 4, v7
    s_cbranch_vccz K2_LW_D
    s_sleep 2
    s_branch K2_LW
K2_LW_D:
    s_lshl_b32 s60, s63, 13
    s_add_u32 m0, s60, 50176
    s_add_u32 s61, s60, 0x1890000
    buffer_load_dwordx4 v5, s[24:27], s61 offen offset:0 sc1 lds
    buffer_load_dwordx4 v5, s[24:27], s61 offen offset:1024 sc1 lds
    buffer_load_dwordx4 v5, s[24:27], s61 offen offset:2048 sc1 lds
    buffer_load_dwordx4 v5, s[24:27], s61 offen offset:3072 sc1 lds
    s_add_u32 m0, s60, 54272
    s_add_u32 s61, s60, 0x1891000
    buffer_load_dwordx4 v5, s[24:27], s61 offen offset:0 sc1 lds
    buffer_load_dwordx4 v5, s[24:27], s61 offen offset:1024 sc1 lds
    s_cmp_eq_u32 s63, 3
    s_cbranch_scc1 K2_LD
    buffer_load_dwordx4 v5, s[24:27], s61 offen offset:2048 sc1 lds
    buffer_load_dwordx4 v5, s[24:27], s61 offen offset:3072 sc1 lds
    s_lshl_b32 s60, s63, 11
    s_add_u32 m0, s60, 44032
    s_lshl_b32 s61, s40, 13
    s_add_u32 s61, s61, s60
    s_add_u32 s61, s61, 0x18a8000
    buffer_load_dwordx4 v5, s[24:27], s61 offen offset:0 sc1 lds
    buffer_load_dwordx4 v5, s[24:27], s61 offen offset:1024 sc1 lds
K2_LD:
K2_JOIN:
    s_setprio 0
    s_mul_i32 s61, s40, 1286144
    s_add_u32 s61, s61, 20578304
    s_add_u32 s16, s14, s61
    s_addc_u32 s17, s15, 0
    s_mov_b32 s18, 0x138800
    s_mov_b32 s19, 0x20000
    v_lshlrev_b32 v20, 3, v1
    v_or_b32 v20, 0x80000000, v20
    s_lshr_b32 s61, s3, 1
    s_mul_i32 s60, s61, 4992
    s_bitcmp0_b32 s3, 0
    s_cselect_b32 s61, 2496, 0
    s_add_u32 s60, s60, s61
    s_add_u32 s60, s60, 3072
    v_lshlrev_b32 v22, 4, v2
    v_add_u32 v22, s60, v22
    s_waitcnt vmcnt(0) lgkmcnt(0)
    s_barrier
    ds_read_b128 v[48:51], v22
    ds_read_b128 v[64:67], v22 offset:192
    s_waitcnt lgkmcnt(1)
    v_xor_b32 v48, v20, v48
    v_lshrrev_b32 v48, 1, v48
    v_xor_b32 v49, v20, v49
    v_lshrrev_b32 v49, 1, v49
    v_xor_b32 v50, v20, v50
    v_lshrrev_b32 v50, 1, v50
    v_xor_b32 v51, v20, v51
    v_lshrrev_b32 v51, 1, v51
    buffer_load_dword v80, v48, s[16:19], 0 offen
    buffer_load_dword v81, v48, s[16:19], 0 offen offset:64
    buffer_load_dword v82, v49, s[16:19], 0 offen
    buffer_load_dword v83, v49, s[16:19], 0 offen offset:64
    buffer_load_dword v84, v50, s[16:19], 0 offen
    buffer_load_dword v85, v50, s[16:19], 0 offen offset:64
    buffer_load_dword v86, v51, s[16:19], 0 offen
    buffer_load_dword v87, v51, s[16:19], 0 offen offset:64
    s_waitcnt lgkmcnt(0)
    v_xor_b32 v64, v20, v64
    v_lshrrev_b32 v64, 1, v64
    v_xor_b32 v65, v20, v65
    v_lshrrev_b32 v65, 1, v65
    v_xor_b32 v66, v20, v66
    v_lshrrev_b32 v66, 1, v66
    v_xor_b32 v67, v20, v67
    v_lshrrev_b32 v67, 1, v67
    buffer_load_dword v96, v64, s[16:19], 0 offen
    buffer_load_dword v97, v64, s[16:19], 0 offen offset:64
    buffer_load_dword v98, v65, s[16:19], 0 offen
    buffer_load_dword v99, v65, s[16:19], 0 offen offset:64
    buffer_load_dword v100, v66, s[16:19], 0 offen
    buffer_load_dword v101, v66, s[16:19], 0 offen offset:64
    buffer_load_dword v102, v67, s[16:19], 0 offen
    buffer_load_dword v103, v67, s[16:19], 0 offen offset:64
    s_lshl_b32 s60, s3, 8
    s_add_u32 s60, s60, s2
    s_lshl_b32 s60, s60, 1
    s_add_u32 s60, s60, s50
    s_cmp_lg_u32 s60, 511
    s_cbranch_scc1 K2_NE
    s_mov_b32 s60, 0x18b7f80
    s_mov_b64 exec, 1
    buffer_store_dword v13, v8, s[24:27], s60 offen sc1
    s_mov_b64 exec, -1
    s_waitcnt vmcnt(0)
K2_NE:
    s_mov_b32 s50, 0
    s_lshr_b32 s60, s3, 1
    s_lshl_b32 s60, s60, 5
    v_lshlrev_b32 v16, 2, v30
    v_and_b32 v16, 28, v16
    ds_read_b32 v18, v16 offset:3008
    v_add_u32 v16, s60, v16
    ds_read_b32 v17, v16 offset:1024
    s_and_b32 s51, s51, 4
    s_cmp_lg_u32 s48, 0
    s_cselect_b32 s60, 1, 0
    s_or_b32 s51, s51, s60
    s_add_u32 s48, s48, s49
    s_waitcnt lgkmcnt(0)
    v_readlane_b32 s60, v18, 4
    v_readlane_b32 s61, v18, 0
    v_readlane_b32 s62, v18, 2
    s_cmp_eq_u32 s60, 1
    s_cbranch_scc1 K2_GO
    s_lshr_b32 s49, s49, 2
    s_max_u32 s49, s49, 1
    s_mov_b32 s48, 0
    s_waitcnt vmcnt(0)
    s_barrier
    s_branch K2_ROUND
K2_GO:
    s_cmp_lt_u32 s48, s61
    s_cselect_b32 s60, 2, 0
    s_or_b32 s51, s51, s60
    s_cmp_eq_u32 s62, 0
    s_cbranch_scc1 K2_FAST
    s_bitset1_b32 s51, 2
    s_mul_i32 s60, s3, 3072
    s_add_u32 m0, s60, 80896
    s_add_u32 s60, s60, 0x1897800
    v_lshlrev_b32 v16, 4, v30
    buffer_load_dwordx4 v16, s[24:27], s60 offen offset:0 lds
    buffer_load_dwordx4 v16, s[24:27], s60 offen offset:1024 lds
    buffer_load_dwordx4 v16, s[24:27], s60 offen offset:2048 lds
    s_waitcnt vmcnt(0)
    s_barrier
K2_FAST:
    v_readlane_b32 s60, v17, 0
    v_readlane_b32 s61, v17, 1
    v_readlane_b32 s62, v17, 2
    v_readlane_b32 s63, v17, 3
    v_readlane_b32 s77, v17, 4
    s_add_u32 s46, s60, s61
    s_add_u32 s79, s62, s63
    s_add_u32 s79, s79, s77
    s_lshl_b32 s61, s61, 8
    s_lshl_b32 s62, s62, 16
    s_lshl_b32 s63, s63, 24
    s_or_b32 s76, s60, s61
    s_or_b32 s62, s62, s63
    s_or_b32 s76, s76, s62
    s_lshl_b32 s60, s40, 7
    s_mov_b32 s61, 80896
    s_mov_b32 s62, 46080
    s_mov_b32 s73, s59
    v_lshlrev_b32 v20, 3, v1
    s_xor_b32 s63, s3, 1
    v_or_b32 v20, 0x80000000, v20
    v_lshlrev_b32 v38, 4, v0
    v_add_u32 v38, s62, v38
    ds_read_b128 v[4:7], v38
    ds_read_b128 v[8:11], v38 offset:1024
    v_lshlrev_b32 v26, 2, v1
    v_add_u32 v12, s61, v26
    s_lshl_b32 s61, s41, 11
    s_add_u32 s60, s60, s61
    v_add_u32 v26, s60, v26
    s_and_b32 s63, s63, 1
    s_cselect_b32 s56, 2, 0
    s_cselect_b32 s58, 5, 2
    s_cselect_b32 s62, 52, 0
    s_cselect_b32 s63, s79, s46
    s_cselect_b32 s60, 16, 0
    s_lshr_b64 s[52:53], s[76:77], s60
    s_lshr_b32 s61, s3, 1
    s_lshl_b32 s60, s61, 3
    s_add_u32 s60, s60, s56
    s_lshl_b32 s60, s60, 4
    v_lshlrev_b32 v29, 2, v2
    v_add_u32 v29, s60, v29
    ds_read_b32 v28, v29 offset:1280
    s_mul_i32 s60, s61, 4992
    s_mul_i32 s62, s62, 48
    s_add_u32 s60, s60, s62
    s_add_u32 s60, s60, 3072
    v_lshlrev_b32 v22, 4, v2
    v_add_u32 v22, s60, v22
    v_lshlrev_b32 v23, 3, v1
    v_add_u32 v23, s60, v23
    ds_read_u16 v40, v23 offset:70
    ds_read_u16 v34, v23 offset:262
    v_mov_b32 v42, 0
    v_mov_b32 v43, 0
    v_mov_b32 v44, 0
    v_mov_b32 v45, 0
    s_and_b32 s54, s52, 255
    s_sub_u32 s54, s54, 1
    s_max_u32 s63, s63, 8
    s_sub_u32 s55, s63, 8
    s_mov_b32 s57, 0
    s_setprio 3
    s_waitcnt lgkmcnt(0)
    v_add_u32 v40, v21, v40
    ds_read_b64 v[30:31], v40
    ds_read_b128 v[48:51], v22 offset:384
    v_lshl_add_u32 v27, v28, 17, v26
    v_lshl_add_u32 v28, v28, 9, v12
    ds_read_b32 v35, v28 offset:0
    ds_read_b32 v36, v28 offset:64
    v_add_u32 v29, 16, v29
    ds_read_b32 v28, v29 offset:1280
K2_ds_IT0:
    s_waitcnt lgkmcnt(0)
    v_mfma_f32_16x16x16_bf16 v[64:67], v[30:31], v[4:5], 0
    v_mfma_f32_16x16x16_bf16 v[68:71], v[30:31], v[6:7], 0
    v_mfma_f32_16x16x16_bf16 v[72:75], v[30:31], v[8:9], 0
    v_mfma_f32_16x16x16_bf16 v[76:79], v[30:31], v[10:11], 0
    v_add_u32 v34, v21, v34
    ds_read_b64 v[30:31], v34
    ds_read_u16 v34, v23 offset:454
    s_sub_u32 s55, s55, 4
    s_cbranch_scc1 K2_ds_NI0
    v_xor_b32 v48, v20, v48
    v_lshrrev_b32 v48, 1, v48
    v_xor_b32 v49, v20, v49
    v_lshrrev_b32 v49, 1, v49
    v_xor_b32 v50, v20, v50
    v_lshrrev_b32 v50, 1, v50
    v_xor_b32 v51, v20, v51
    v_lshrrev_b32 v51, 1, v51
    buffer_load_dword v112, v48, s[16:19], 0 offen
    buffer_load_dword v113, v48, s[16:19], 0 offen offset:64
    buffer_load_dword v114, v49, s[16:19], 0 offen
    buffer_load_dword v115, v49, s[16:19], 0 offen offset:64
    buffer_load_dword v116, v50, s[16:19], 0 offen
    buffer_load_dword v117, v50, s[16:19], 0 offen offset:64
    buffer_load_dword v118, v51, s[16:19], 0 offen
    buffer_load_dword v119, v51, s[16:19], 0 offen offset:64
    ds_read_b128 v[48:51], v22 offset:576
    s_cmp_eq_u32 s57, 0
    s_cbranch_scc1 K2_ds_W0
    s_waitcnt vmcnt(18)
K2_ds_C0:
    s_lshr_b32 s57, s57, 1
    v_lshlrev_b32 v38, 16, v80
    v_and_b32 v39, v3, v80
    v_fmac_f32 v42, v38, v64
    v_fmac_f32 v43, v39, v68
    v_lshlrev_b32 v40, 16, v81
    v_and_b32 v41, v3, v81
    v_fmac_f32 v44, v40, v72
    v_fmac_f32 v45, v41, v76
    s_sub_u32 s54, s54, 1
    s_cbranch_scc1 K2_ds_B0_0
K2_ds_R0_0:
    v_lshlrev_b32 v38, 16, v82
    v_and_b32 v39, v3, v82
    v_fmac_f32 v42, v38, v65
    v_fmac_f32 v43, v39, v69
    v_lshlrev_b32 v40, 16, v83
    v_and_b32 v41, v3, v83
    v_fmac_f32 v44, v40, v73
    v_fmac_f32 v45, v41, v77
    s_sub_u32 s54, s54, 1
    s_cbranch_scc1 K2_ds_B0_1
K2_ds_R0_1:
    v_lshlrev_b32 v38, 16, v84
    v_and_b32 v39, v3, v84
    v_fmac_f32 v42, v38, v66
    v_fmac_f32 v43, v39, v70
    v_lshlrev_b32 v40, 16, v85
    v_and_b32 v41, v3, v85
    v_fmac_f32 v44, v40, v74
    v_fmac_f32 v45, v41, v78
    s_sub_u32 s54, s54, 1
    s_cbranch_scc1 K2_ds_B0_2
K2_ds_R0_2:
    v_lshlrev_b32 v38, 16, v86
    v_and_b32 v39, v3, v86
    v_fmac_f32 v42, v38, v67
    v_fmac_f32 v43, v39, v71
    v_lshlrev_b32 v40, 16, v87
    v_and_b32 v41, v3, v87
    v_fmac_f32 v44, v40, v75
    v_fmac_f32 v45, v41, v79
    s_sub_u32 s54, s54, 1
    s_cbranch_scc1 K2_ds_B0_3
K2_ds_IT1:
    s_waitcnt lgkmcnt(0)
    v_mfma_f32_16x16x16_bf16 v[64:67], v[30:31], v[4:5], 0
    v_mfma_f32_16x16x16_bf16 v[68:71], v[30:31], v[6:7], 0
    v_mfma_f32_16x16x16_bf16 v[72:75], v[30:31], v[8:9], 0
    v_mfma_f32_16x16x16_bf16 v[76:79], v[30:31], v[10:11], 0
    v_add_u32 v34, v21, v34
    ds_read_b64 v[30:31], v34
    ds_read_u16 v34, v23 offset:646
    s_sub_u32 s55, s55, 4
    s_cbranch_scc1 K2_ds_NI1
    v_xor_b32 v48, v20, v48
    v_lshrrev_b32 v48, 1, v48
    v_xor_b32 v49, v20, v49
    v_lshrrev_b32 v49, 1, v49
    v_xor_b32 v50, v20, v50
    v_lshrrev_b32 v50, 1, v50
    v_xor_b32 v51, v20, v51
    v_lshrrev_b32 v51, 1, v51
    buffer_load_dword v80, v48, s[16:19], 0 offen
    buffer_load_dword v81, v48, s[16:19], 0 offen offset:64
    buffer_load_dword v82, v49, s[16:19], 0 offen
    buffer_load_dword v83, v49, s[16:19], 0 offen offset:64
    buffer_load_dword v84, v50, s[16:19], 0 offen
    buffer_load_dword v85, v50, s[16:19], 0 offen offset:64
    buffer_load_dword v86, v51, s[16:19], 0 offen
    buffer_load_dword v87, v51, s[16:19], 0 offen offset:64
    ds_read_b128 v[48:51], v22 offset:768
    s_cmp_eq_u32 s57, 0
    s_cbranch_scc1 K2_ds_W1
    s_waitcnt vmcnt(18)
K2_ds_C1:
    s_lshr_b32 s57, s57, 1
    v_lshlrev_b32 v38, 16, v96
    v_and_b32 v39, v3, v96
    v_fmac_f32 v42, v38, v64
    v_fmac_f32 v43, v39, v68
    v_lshlrev_b32 v40, 16, v97
    v_and_b32 v41, v3, v97
    v_fmac_f32 v44, v40, v72
    v_fmac_f32 v45, v41, v76
    s_sub_u32 s54, s54, 1
    s_cbranch_scc1 K2_ds_B1_0
K2_ds_R1_0:
    v_lshlrev_b32 v38, 16, v98
    v_and_b32 v39, v3, v98
    v_fmac_f32 v42, v38, v65
    v_fmac_f32 v43, v39, v69
    v_lshlrev_b32 v40, 16, v99
    v_and_b32 v41, v3, v99
    v_fmac_f32 v44, v40, v73
    v_fmac_f32 v45, v41, v77
    s_sub_u32 s54, s54, 1
    s_cbranch_scc1 K2_ds_B1_1
K2_ds_R1_1:
    v_lshlrev_b32 v38, 16, v100
    v_and_b32 v39, v3, v100
    v_fmac_f32 v42, v38, v66
    v_fmac_f32 v43, v39, v70
    v_lshlrev_b32 v40, 16, v101
    v_and_b32 v41, v3, v101
    v_fmac_f32 v44, v40, v74
    v_fmac_f32 v45, v41, v78
    s_sub_u32 s54, s54, 1
    s_cbranch_scc1 K2_ds_B1_2
K2_ds_R1_2:
    v_lshlrev_b32 v38, 16, v102
    v_and_b32 v39, v3, v102
    v_fmac_f32 v42, v38, v67
    v_fmac_f32 v43, v39, v71
    v_lshlrev_b32 v40, 16, v103
    v_and_b32 v41, v3, v103
    v_fmac_f32 v44, v40, v75
    v_fmac_f32 v45, v41, v79
    s_sub_u32 s54, s54, 1
    s_cbranch_scc1 K2_ds_B1_3
K2_ds_IT2:
    s_waitcnt lgkmcnt(0)
    v_mfma_f32_16x16x16_bf16 v[64:67], v[30:31], v[4:5], 0
    v_mfma_f32_16x16x16_bf16 v[68:71], v[30:31], v[6:7], 0
    v_mfma_f32_16x16x16_bf16 v[72:75], v[30:31], v[8:9], 0
    v_mfma_f32_16x16x16_bf16 v[76:79], v[30:31], v[10:11], 0
    v_add_u32 v34, v21, v34
    ds_read_b64 v[30:31], v34
    ds_read_u16 v34, v23 offset:838
    v_add_u32 v23, 576, v23
    s_sub_u32 s55, s55, 4
    s_cbranch_scc1 K2_ds_NI2
    v_xor_b32 v48, v20, v48
    v_lshrrev_b32 v48, 1, v48
    v_xor_b32 v49, v20, v49
    v_lshrrev_b32 v49, 1, v49
    v_xor_b32 v50, v20, v50
    v_lshrrev_b32 v50, 1, v50
    v_xor_b32 v51, v20, v51
    v_lshrrev_b32 v51, 1, v51
    buffer_load_dword v96, v48, s[16:19], 0 offen
    buffer_load_dword v97, v48, s[16:19], 0 offen offset:64
    buffer_load_dword v98, v49, s[16:19], 0 offen
    buffer_load_dword v99, v49, s[16:19], 0 offen offset:64
    buffer_load_dword v100, v50, s[16:19], 0 offen
    buffer_load_dword v101, v50, s[16:19], 0 offen offset:64
    buffer_load_dword v102, v51, s[16:19], 0 offen
    buffer_load_dword v103, v51, s[16:19], 0 offen offset:64
    ds_read_b128 v[48:51], v22 offset:960
    v_add_u32 v22, 576, v22
    s_cmp_eq_u32 s57, 0
    s_cbranch_scc1 K2_ds_W2
    s_waitcnt vmcnt(18)
K2_ds_C2:
    s_lshr_b32 s57, s57, 1
    v_lshlrev_b32 v38, 16, v112
    v_and_b32 v39, v3, v112
    v_fmac_f32 v42, v38, v64
    v_fmac_f32 v43, v39, v68
    v_lshlrev_b32 v40, 16, v113
    v_and_b32 v41, v3, v113
    v_fmac_f32 v44, v40, v72
    v_fmac_f32 v45, v41, v76
    s_sub_u32 s54, s54, 1
    s_cbranch_scc1 K2_ds_B2_0
K2_ds_R2_0:
    v_lshlrev_b32 v38, 16, v114
    v_and_b32 v39, v3, v114
    v_fmac_f32 v42, v38, v65
    v_fmac_f32 v43, v39, v69
    v_lshlrev_b32 v40, 16, v115
    v_and_b32 v41, v3, v115
    v_fmac_f32 v44, v40, v73
    v_fmac_f32 v45, v41, v77
    s_sub_u32 s54, s54, 1
    s_cbranch_scc1 K2_ds_B2_1
K2_ds_R2_1:
    v_lshlrev_b32 v38, 16, v116
    v_and_b32 v39, v3, v116
    v_fmac_f32 v42, v38, v66
    v_fmac_f32 v43, v39, v70
    v_lshlrev_b32 v40, 16, v117
    v_and_b32 v41, v3, v117
    v_fmac_f32 v44, v40, v74
    v_fmac_f32 v45, v41, v78
    s_sub_u32 s54, s54, 1
    s_cbranch_scc1 K2_ds_B2_2
K2_ds_R2_2:
    v_lshlrev_b32 v38, 16, v118
    v_and_b32 v39, v3, v118
    v_fmac_f32 v42, v38, v67
    v_fmac_f32 v43, v39, v71
    v_lshlrev_b32 v40, 16, v119
    v_and_b32 v41, v3, v119
    v_fmac_f32 v44, v40, v75
    v_fmac_f32 v45, v41, v79
    s_sub_u32 s54, s54, 1
    s_cbranch_scc1 K2_ds_B2_3
    s_branch K2_ds_IT0
K2_ds_W0:
    s_waitcnt vmcnt(16)
    s_branch K2_ds_C0
K2_ds_NI0:
    s_cmp_eq_i32 s55, -4
    s_cbranch_scc1 K2_ds_NZ0
    v_xor_b32 v48, v20, v48
    v_lshrrev_b32 v48, 1, v48
    buffer_load_dword v112, v48, s[16:19], 0 offen
    buffer_load_dword v113, v48, s[16:19], 0 offen offset:64
    s_cmp_eq_i32 s55, -3
    s_cbranch_scc1 K2_ds_NP0
    v_xor_b32 v49, v20, v49
    v_lshrrev_b32 v49, 1, v49
    buffer_load_dword v114, v49, s[16:19], 0 offen
    buffer_load_dword v115, v49, s[16:19], 0 offen offset:64
    s_cmp_eq_i32 s55, -2
    s_cbranch_scc1 K2_ds_NP0
    v_xor_b32 v50, v20, v50
    v_lshrrev_b32 v50, 1, v50
    buffer_load_dword v116, v50, s[16:19], 0 offen
    buffer_load_dword v117, v50, s[16:19], 0 offen offset:64
K2_ds_NP0:
    s_mov_b32 s55, 0
    s_waitcnt vmcnt(10)
    s_branch K2_ds_C0
K2_ds_NZ0:
    s_mov_b32 s55, 0
    s_waitcnt vmcnt(0)
    s_nop 1
    s_branch K2_ds_C0
K2_ds_B0_0:
    s_call_b64 s[42:43], K2_ds_Q0
    s_cbranch_scc1 K2_ds_DONE
    s_branch K2_ds_R0_0
K2_ds_B0_1:
    s_call_b64 s[42:43], K2_ds_Q0
    s_cbranch_scc1 K2_ds_DONE
    s_branch K2_ds_R0_1
K2_ds_B0_2:
    s_call_b64 s[42:43], K2_ds_Q0
    s_cbranch_scc1 K2_ds_DONE
    s_branch K2_ds_R0_2
K2_ds_B0_3:
    s_call_b64 s[42:43], K2_ds_Q0
    s_cbranch_scc1 K2_ds_DONE
    s_branch K2_ds_IT1
K2_ds_W1:
    s_waitcnt vmcnt(16)
    s_branch K2_ds_C1
K2_ds_NI1:
    s_cmp_eq_i32 s55, -4
    s_cbranch_scc1 K2_ds_NZ1
    v_xor_b32 v48, v20, v48
    v_lshrrev_b32 v48, 1, v48
    buffer_load_dword v80, v48, s[16:19], 0 offen
    buffer_load_dword v81, v48, s[16:19], 0 offen offset:64
    s_cmp_eq_i32 s55, -3
    s_cbranch_scc1 K2_ds_NP1
    v_xor_b32 v49, v20, v49
    v_lshrrev_b32 v49, 1, v49
    buffer_load_dword v82, v49, s[16:19], 0 offen
    buffer_load_dword v83, v49, s[16:19], 0 offen offset:64
    s_cmp_eq_i32 s55, -2
    s_cbranch_scc1 K2_ds_NP1
    v_xor_b32 v50, v20, v50
    v_lshrrev_b32 v50, 1, v50
    buffer_load_dword v84, v50, s[16:19], 0 offen
    buffer_load_dword v85, v50, s[16:19], 0 offen offset:64
K2_ds_NP1:
    s_mov_b32 s55, 0
    s_waitcnt vmcnt(10)
    s_branch K2_ds_C1
K2_ds_NZ1:
    s_mov_b32 s55, 0
    s_waitcnt vmcnt(0)
    s_nop 1
    s_branch K2_ds_C1
K2_ds_B1_0:
    s_call_b64 s[42:43], K2_ds_Q0
    s_cbranch_scc1 K2_ds_DONE
    s_branch K2_ds_R1_0
K2_ds_B1_1:
    s_call_b64 s[42:43], K2_ds_Q0
    s_cbranch_scc1 K2_ds_DONE
    s_branch K2_ds_R1_1
K2_ds_B1_2:
    s_call_b64 s[42:43], K2_ds_Q0
    s_cbranch_scc1 K2_ds_DONE
    s_branch K2_ds_R1_2
K2_ds_B1_3:
    s_call_b64 s[42:43], K2_ds_Q0
    s_cbranch_scc1 K2_ds_DONE
    s_branch K2_ds_IT2
K2_ds_W2:
    s_waitcnt vmcnt(16)
    s_branch K2_ds_C2
K2_ds_NI2:
    s_cmp_eq_i32 s55, -4
    s_cbranch_scc1 K2_ds_NZ2
    v_xor_b32 v48, v20, v48
    v_lshrrev_b32 v48, 1, v48
    buffer_load_dword v96, v48, s[16:19], 0 offen
    buffer_load_dword v97, v48, s[16:19], 0 offen offset:64
    s_cmp_eq_i32 s55, -3
    s_cbranch_scc1 K2_ds_NP2
    v_xor_b32 v49, v20, v49
    v_lshrrev_b32 v49, 1, v49
    buffer_load_dword v98, v49, s[16:19], 0 offen
    buffer_load_dword v99, v49, s[16:19], 0 offen offset:64
    s_cmp_eq_i32 s55, -2
    s_cbranch_scc1 K2_ds_NP2
    v_xor_b32 v50, v20, v50
    v_lshrrev_b32 v50, 1, v50
    buffer_load_dword v100, v50, s[16:19], 0 offen
    buffer_load_dword v101, v50, s[16:19], 0 offen offset:64
K2_ds_NP2:
    s_mov_b32 s55, 0
    s_waitcnt vmcnt(10)
    s_branch K2_ds_C2
K2_ds_NZ2:
    s_mov_b32 s55, 0
    s_waitcnt vmcnt(0)
    s_nop 1
    s_branch K2_ds_C2
K2_ds_B2_0:
    s_call_b64 s[42:43], K2_ds_Q0
    s_cbranch_scc1 K2_ds_DONE
    s_branch K2_ds_R2_0
K2_ds_B2_1:
    s_call_b64 s[42:43], K2_ds_Q0
    s_cbranch_scc1 K2_ds_DONE
    s_branch K2_ds_R2_1
K2_ds_B2_2:
    s_call_b64 s[42:43], K2_ds_Q0
    s_cbranch_scc1 K2_ds_DONE
    s_branch K2_ds_R2_2
K2_ds_B2_3:
    s_call_b64 s[42:43], K2_ds_Q0
    s_cbranch_scc1 K2_ds_DONE
    s_branch K2_ds_IT0
K2_ds_Q0:
    s_waitcnt lgkmcnt(0)
    s_add_u32 s56, s56, 1
    s_lshr_b64 s[52:53], s[52:53], 8
    s_and_b32 s54, s52, 255
    s_sub_u32 s54, s54, 1
    s_bitset1_b32 s57, 1
    s_cmp_lg_u32 s51, 0
    s_cbranch_scc1 K2_ds_SLOW
K2_ds_FIN:
    v_lshlrev_b32 v38, 16, v35
    v_and_b32 v39, v3, v35
    v_add_f32 v38, v38, v42
    v_add_f32 v39, v39, v43
    v_cvt_pk_bf16_f32 v52, v38, v39
    buffer_store_dword v52, v27, s[32:35], 0 offen offset:0 sc1
    v_lshlrev_b32 v40, 16, v36
    v_and_b32 v41, v3, v36
    v_add_f32 v40, v40, v44
    v_add_f32 v41, v41, v45
    v_cvt_pk_bf16_f32 v53, v40, v41
    buffer_store_dword v53, v27, s[32:35], 0 offen offset:64 sc1
K2_ds_NXT:
    s_cmp_ge_u32 s56, s58
    s_cbranch_scc1 K2_ds_RET
    v_lshl_add_u32 v27, v28, 17, v26
    v_lshl_add_u32 v28, v28, 9, v12
    ds_read_b32 v35, v28 offset:0
    ds_read_b32 v36, v28 offset:64
    v_add_u32 v29, 16, v29
    ds_read_b32 v28, v29 offset:1280
    v_mov_b32 v42, 0
    v_mov_b32 v43, 0
    v_mov_b32 v44, 0
    v_mov_b32 v45, 0
K2_ds_RET:
    s_setpc_b64 s[42:43]
K2_ds_SLOW:
    v_sub_u32 v38, v27, v26
    v_lshrrev_b32 v38, 7, v38
    v_lshl_add_u32 v38, v1, 3, v38
    s_bitcmp0_b32 s51, 0
    s_cbranch_scc1 K2_ds_SL1
    buffer_load_dwordx2 v[56:57], v38, s[24:27], s73 offen offset:0
    buffer_load_dwordx2 v[58:59], v38, s[24:27], s73 offen offset:128
    s_waitcnt vmcnt(0)
    v_add_f32 v42, v42, v56
    v_add_f32 v43, v43, v57
    v_add_f32 v44, v44, v58
    v_add_f32 v45, v45, v59
K2_ds_SL1:
    s_bitcmp1_b32 s51, 1
    s_cbranch_scc1 K2_ds_SL2
    s_bitcmp0_b32 s51, 2
    s_cbranch_scc1 K2_ds_FIN
    buffer_load_dword v35, v27, s[28:31], 0 offen offset:0
    buffer_load_dword v36, v27, s[28:31], 0 offen offset:64
    s_waitcnt vmcnt(0)
    s_branch K2_ds_FIN
K2_ds_SL2:
    buffer_store_dwordx2 v[42:43], v38, s[24:27], s73 offen offset:0
    buffer_store_dwordx2 v[44:45], v38, s[24:27], s73 offen offset:128
    s_waitcnt vmcnt(0)
    s_branch K2_ds_NXT
K2_ds_DONE:
    s_setprio 2
    s_mov_b32 s72, 0
K2_dv_PH:
    s_lshl_b32 s60, s40, 1
    s_add_u32 s60, s60, s72
    s_mul_i32 s61, s60, 2572288
    s_add_u32 s16, s14, s61
    s_addc_u32 s17, s15, 0
    s_mov_b32 s18, 0x271000
    s_mov_b32 s19, 0x20000
    s_lshl_b32 s60, s60, 6
    s_add_u32 s60, s60, 512
    s_lshl_b32 s61, s72, 6
    s_add_u32 s61, s61, 81024
    s_lshl_b32 s62, s72, 12
    s_add_u32 s62, s62, 44032
    s_mul_i32 s73, s72, 384
    s_add_u32 s73, s73, 256
    s_add_u32 s73, s73, s59
    v_lshlrev_b32 v20, 4, v1
    s_xor_b32 s63, s3, s72
    v_or_b32 v20, 0x80000000, v20
    v_lshlrev_b32 v38, 4, v0
    v_add_u32 v38, s62, v38
    ds_read_b128 v[4:7], v38
    ds_read_b128 v[8:11], v38 offset:1024
    v_lshlrev_b32 v26, 2, v1
    v_add_u32 v12, s61, v26
    s_lshl_b32 s61, s41, 11
    s_add_u32 s60, s60, s61
    v_add_u32 v26, s60, v26
    s_and_b32 s63, s63, 1
    s_cselect_b32 s56, 2, 0
    s_cselect_b32 s58, 5, 2
    s_cselect_b32 s62, 52, 0
    s_cselect_b32 s63, s79, s46
    s_cselect_b32 s60, 16, 0
    s_lshr_b64 s[52:53], s[76:77], s60
    s_lshr_b32 s61, s3, 1
    s_lshl_b32 s60, s61, 3
    s_add_u32 s60, s60, s56
    s_lshl_b32 s60, s60, 4
    v_lshlrev_b32 v29, 2, v2
    v_add_u32 v29, s60, v29
    ds_read_b32 v28, v29 offset:1280
    s_mul_i32 s60, s61, 4992
    s_mul_i32 s62, s62, 48
    s_add_u32 s60, s60, s62
    s_add_u32 s60, s60, 3072
    v_lshlrev_b32 v22, 4, v2
    v_add_u32 v22, s60, v22
    v_lshlrev_b32 v23, 3, v1
    v_add_u32 v23, s60, v23
    ds_read_b128 v[48:51], v22
    ds_read_b128 v[64:67], v22 offset:192
    ds_read_u16 v40, v23 offset:70
    ds_read_u16 v34, v23 offset:262
    v_and_b32 v38, 3, v1
    v_lshrrev_b32 v39, 2, v1
    v_cmp_eq_u32 vcc, v38, v2
    v_lshlrev_b32 v38, 5, v38
    v_lshl_add_u32 v38, v39, 3, v38
    v_add_u32 v38, s60, v38
    v_mov_b32 v39, 43008
    v_cndmask_b32 v24, v39, v38, vcc
    v_mov_b32 v39, 576
    v_cndmask_b32 v25, 0, v39, vcc
    v_mov_b32 v42, 0
    v_mov_b32 v43, 0
    v_mov_b32 v44, 0
    v_mov_b32 v45, 0
    v_mov_b32 v46, 0
    v_mov_b32 v47, 0
    v_mov_b32 v56, 0
    v_mov_b32 v57, 0
    v_mov_b32 v58, 0
    v_mov_b32 v60, 0
    v_mov_b32 v61, 0
    v_mov_b32 v62, 0
    s_and_b32 s54, s52, 255
    s_sub_u32 s54, s54, 1
    s_max_u32 s63, s63, 8
    s_sub_u32 s55, s63, 8
    s_mov_b32 s57, 0
    s_waitcnt lgkmcnt(0)
    v_add_u32 v40, v21, v40
    ds_read_b64 v[30:31], v40
    v_xor_b32 v48, v20, v48
    v_xor_b32 v49, v20, v49
    v_xor_b32 v50, v20, v50
    v_xor_b32 v51, v20, v51
    buffer_load_dwordx4 v[80:83], v48, s[16:19], 0 offen
    buffer_load_dwordx4 v[84:87], v49, s[16:19], 0 offen
    buffer_load_dwordx4 v[88:91], v50, s[16:19], 0 offen
    buffer_load_dwordx4 v[92:95], v51, s[16:19], 0 offen
    ds_read_b128 v[48:51], v22 offset:384
    v_xor_b32 v64, v20, v64
    v_xor_b32 v65, v20, v65
    v_xor_b32 v66, v20, v66
    v_xor_b32 v67, v20, v67
    buffer_load_dwordx4 v[96:99], v64, s[16:19], 0 offen
    buffer_load_dwordx4 v[100:103], v65, s[16:19], 0 offen
    buffer_load_dwordx4 v[104:107], v66, s[16:19], 0 offen
    buffer_load_dwordx4 v[108:111], v67, s[16:19], 0 offen
    v_lshl_add_u32 v27, v28, 17, v26
    v_lshl_add_u32 v28, v28, 9, v12
    ds_read_b32 v35, v28 offset:0
    ds_read_b32 v36, v28 offset:128
    ds_read_b32 v37, v28 offset:256
    v_add_u32 v29, 16, v29
    ds_read_b32 v28, v29 offset:1280
K2_dv_IT0:
    s_waitcnt lgkmcnt(0)
    v_mfma_f32_16x16x16_bf16 v[64:67], v[30:31], v[4:5], 0
    v_mfma_f32_16x16x16_bf16 v[68:71], v[30:31], v[6:7], 0
    v_mfma_f32_16x16x16_bf16 v[72:75], v[30:31], v[8:9], 0
    v_mfma_f32_16x16x16_bf16 v[76:79], v[30:31], v[10:11], 0
    v_add_u32 v34, v21, v34
    ds_read_b64_tr_b16 v[32:33], v24 offset:64
    ds_read_b64 v[30:31], v34
    ds_read_u16 v34, v23 offset:454
    s_sub_u32 s55, s55, 4
    s_cbranch_scc1 K2_dv_NI0
    v_xor_b32 v48, v20, v48
    v_xor_b32 v49, v20, v49
    v_xor_b32 v50, v20, v50
    v_xor_b32 v51, v20, v51
    buffer_load_dwordx4 v[112:115], v48, s[16:19], 0 offen
    buffer_load_dwordx4 v[116:119], v49, s[16:19], 0 offen
    buffer_load_dwordx4 v[120:123], v50, s[16:19], 0 offen
    buffer_load_dwordx4 v[124:127], v51, s[16:19], 0 offen
    ds_read_b128 v[48:51], v22 offset:576
    s_cmp_eq_u32 s57, 0
    s_cbranch_scc1 K2_dv_W0
    s_waitcnt vmcnt(11)
K2_dv_C0:
    s_lshr_b32 s57, s57, 1
    v_lshlrev_b32 v38, 16, v80
    v_and_b32 v39, v3, v80
    v_mul_f32 v72, v38, v72
    v_mul_f32 v76, v39, v76
    v_lshlrev_b32 v40, 16, v81
    v_fmac_f32 v42, v40, v64
    v_fmac_f32 v43, v81, v68
    v_lshlrev_b32 v38, 16, v82
    v_fmac_f32 v44, v38, v64
    v_fmac_f32 v45, v82, v68
    v_lshlrev_b32 v40, 16, v83
    v_fmac_f32 v46, v40, v64
    v_fmac_f32 v47, v83, v68
    s_sub_u32 s54, s54, 1
    s_cbranch_scc1 K2_dv_B0_0
K2_dv_R0_0:
    v_lshlrev_b32 v38, 16, v84
    v_and_b32 v39, v3, v84
    v_mul_f32 v73, v38, v73
    v_mul_f32 v77, v39, v77
    v_lshlrev_b32 v40, 16, v85
    v_fmac_f32 v42, v40, v65
    v_fmac_f32 v43, v85, v69
    v_lshlrev_b32 v38, 16, v86
    v_fmac_f32 v44, v38, v65
    v_fmac_f32 v45, v86, v69
    v_lshlrev_b32 v40, 16, v87
    v_fmac_f32 v46, v40, v65
    v_fmac_f32 v47, v87, v69
    s_sub_u32 s54, s54, 1
    s_cbranch_scc1 K2_dv_B0_1
K2_dv_R0_1:
    v_lshlrev_b32 v38, 16, v88
    v_and_b32 v39, v3, v88
    v_mul_f32 v74, v38, v74
    v_mul_f32 v78, v39, v78
    v_lshlrev_b32 v40, 16, v89
    v_fmac_f32 v42, v40, v66
    v_fmac_f32 v43, v89, v70
    v_lshlrev_b32 v38, 16, v90
    v_fmac_f32 v44, v38, v66
    v_fmac_f32 v45, v90, v70
    v_lshlrev_b32 v40, 16, v91
    v_fmac_f32 v46, v40, v66
    v_fmac_f32 v47, v91, v70
    s_sub_u32 s54, s54, 1
    s_cbranch_scc1 K2_dv_B0_2
K2_dv_R0_2:
    v_lshlrev_b32 v38, 16, v92
    v_and_b32 v39, v3, v92
    v_mul_f32 v75, v38, v75
    v_mul_f32 v79, v39, v79
    v_lshlrev_b32 v40, 16, v93
    v_fmac_f32 v42, v40, v67
    v_fmac_f32 v43, v93, v71
    v_lshlrev_b32 v38, 16, v94
    v_fmac_f32 v44, v38, v67
    v_fmac_f32 v45, v94, v71
    v_lshlrev_b32 v40, 16, v95
    v_fmac_f32 v46, v40, v67
    v_fmac_f32 v47, v95, v71
    s_sub_u32 s54, s54, 1
    s_cbranch_scc1 K2_dv_B0_3
    v_cvt_pk_bf16_f32 v52, v72, v73
    v_cvt_pk_bf16_f32 v53, v74, v75
    v_cvt_pk_bf16_f32 v54, v76, v77
    v_cvt_pk_bf16_f32 v55, v78, v79
    s_waitcnt lgkmcnt(0)
    s_nop 0
    v_mfma_f32_16x16x16_bf16 v[56:59], v[32:33], v[52:53], v[56:59]
    v_mfma_f32_16x16x16_bf16 v[60:63], v[32:33], v[54:55], v[60:63]
K2_dv_IT1:
    s_waitcnt lgkmcnt(0)
    v_mfma_f32_16x16x16_bf16 v[64:67], v[30:31], v[4:5], 0
    v_mfma_f32_16x16x16_bf16 v[68:71], v[30:31], v[6:7], 0
    v_mfma_f32_16x16x16_bf16 v[72:75], v[30:31], v[8:9], 0
    v_mfma_f32_16x16x16_bf16 v[76:79], v[30:31], v[10:11], 0
    v_add_u32 v34, v21, v34
    ds_read_b64_tr_b16 v[32:33], v24 offset:256
    ds_read_b64 v[30:31], v34
    ds_read_u16 v34, v23 offset:646
    s_sub_u32 s55, s55, 4
    s_cbranch_scc1 K2_dv_NI1
    v_xor_b32 v48, v20, v48
    v_xor_b32 v49, v20, v49
    v_xor_b32 v50, v20, v50
    v_xor_b32 v51, v20, v51
    buffer_load_dwordx4 v[80:83], v48, s[16:19], 0 offen
    buffer_load_dwordx4 v[84:87], v49, s[16:19], 0 offen
    buffer_load_dwordx4 v[88:91], v50, s[16:19], 0 offen
    buffer_load_dwordx4 v[92:95], v51, s[16:19], 0 offen
    ds_read_b128 v[48:51], v22 offset:768
    s_cmp_eq_u32 s57, 0
    s_cbranch_scc1 K2_dv_W1
    s_waitcnt vmcnt(11)
K2_dv_C1:
    s_lshr_b32 s57, s57, 1
    v_lshlrev_b32 v38, 16, v96
    v_and_b32 v39, v3, v96
    v_mul_f32 v72, v38, v72
    v_mul_f32 v76, v39, v76
    v_lshlrev_b32 v40, 16, v97
    v_fmac_f32 v42, v40, v64
    v_fmac_f32 v43, v97, v68
    v_lshlrev_b32 v38, 16, v98
    v_fmac_f32 v44, v38, v64
    v_fmac_f32 v45, v98, v68
    v_lshlrev_b32 v40, 16, v99
    v_fmac_f32 v46, v40, v64
    v_fmac_f32 v47, v99, v68
    s_sub_u32 s54, s54, 1
    s_cbranch_scc1 K2_dv_B1_0
K2_dv_R1_0:
    v_lshlrev_b32 v38, 16, v100
    v_and_b32 v39, v3, v100
    v_mul_f32 v73, v38, v73
    v_mul_f32 v77, v39, v77
    v_lshlrev_b32 v40, 16, v101
    v_fmac_f32 v42, v40, v65
    v_fmac_f32 v43, v101, v69
    v_lshlrev_b32 v38, 16, v102
    v_fmac_f32 v44, v38, v65
    v_fmac_f32 v45, v102, v69
    v_lshlrev_b32 v40, 16, v103
    v_fmac_f32 v46, v40, v65
    v_fmac_f32 v47, v103, v69
    s_sub_u32 s54, s54, 1
    s_cbranch_scc1 K2_dv_B1_1
K2_dv_R1_1:
    v_lshlrev_b32 v38, 16, v104
    v_and_b32 v39, v3, v104
    v_mul_f32 v74, v38, v74
    v_mul_f32 v78, v39, v78
    v_lshlrev_b32 v40, 16, v105
    v_fmac_f32 v42, v40, v66
    v_fmac_f32 v43, v105, v70
    v_lshlrev_b32 v38, 16, v106
    v_fmac_f32 v44, v38, v66
    v_fmac_f32 v45, v106, v70
    v_lshlrev_b32 v40, 16, v107
    v_fmac_f32 v46, v40, v66
    v_fmac_f32 v47, v107, v70
    s_sub_u32 s54, s54, 1
    s_cbranch_scc1 K2_dv_B1_2
K2_dv_R1_2:
    v_lshlrev_b32 v38, 16, v108
    v_and_b32 v39, v3, v108
    v_mul_f32 v75, v38, v75
    v_mul_f32 v79, v39, v79
    v_lshlrev_b32 v40, 16, v109
    v_fmac_f32 v42, v40, v67
    v_fmac_f32 v43, v109, v71
    v_lshlrev_b32 v38, 16, v110
    v_fmac_f32 v44, v38, v67
    v_fmac_f32 v45, v110, v71
    v_lshlrev_b32 v40, 16, v111
    v_fmac_f32 v46, v40, v67
    v_fmac_f32 v47, v111, v71
    s_sub_u32 s54, s54, 1
    s_cbranch_scc1 K2_dv_B1_3
    v_cvt_pk_bf16_f32 v52, v72, v73
    v_cvt_pk_bf16_f32 v53, v74, v75
    v_cvt_pk_bf16_f32 v54, v76, v77
    v_cvt_pk_bf16_f32 v55, v78, v79
    s_waitcnt lgkmcnt(0)
    s_nop 0
    v_mfma_f32_16x16x16_bf16 v[56:59], v[32:33], v[52:53], v[56:59]
    v_mfma_f32_16x16x16_bf16 v[60:63], v[32:33], v[54:55], v[60:63]
K2_dv_IT2:
    s_waitcnt lgkmcnt(0)
    v_mfma_f32_16x16x16_bf16 v[64:67], v[30:31], v[4:5], 0
    v_mfma_f32_16x16x16_bf16 v[68:71], v[30:31], v[6:7], 0
    v_mfma_f32_16x16x16_bf16 v[72:75], v[30:31], v[8:9], 0
    v_mfma_f32_16x16x16_bf16 v[76:79], v[30:31], v[10:11], 0
    v_add_u32 v34, v21, v34
    ds_read_b64_tr_b16 v[32:33], v24 offset:448
    ds_read_b64 v[30:31], v34
    ds_read_u16 v34, v23 offset:838
    v_add_u32 v23, 576, v23
    v_add_u32 v24, v25, v24
    s_sub_u32 s55, s55, 4
    s_cbranch_scc1 K2_dv_NI2
    v_xor_b32 v48, v20, v48
    v_xor_b32 v49, v20, v49
    v_xor_b32 v50, v20, v50
    v_xor_b32 v51, v20, v51
    buffer_load_dwordx4 v[96:99], v48, s[16:19], 0 offen
    buffer_load_dwordx4 v[100:103], v49, s[16:19], 0 offen
    buffer_load_dwordx4 v[104:107], v50, s[16:19], 0 offen
    buffer_load_dwordx4 v[108:111], v51, s[16:19], 0 offen
    ds_read_b128 v[48:51], v22 offset:960
    v_add_u32 v22, 576, v22
    s_cmp_eq_u32 s57, 0
    s_cbranch_scc1 K2_dv_W2
    s_waitcnt vmcnt(11)
K2_dv_C2:
    s_lshr_b32 s57, s57, 1
    v_lshlrev_b32 v38, 16, v112
    v_and_b32 v39, v3, v112
    v_mul_f32 v72, v38, v72
    v_mul_f32 v76, v39, v76
    v_lshlrev_b32 v40, 16, v113
    v_fmac_f32 v42, v40, v64
    v_fmac_f32 v43, v113, v68
    v_lshlrev_b32 v38, 16, v114
    v_fmac_f32 v44, v38, v64
    v_fmac_f32 v45, v114, v68
    v_lshlrev_b32 v40, 16, v115
    v_fmac_f32 v46, v40, v64
    v_fmac_f32 v47, v115, v68
    s_sub_u32 s54, s54, 1
    s_cbranch_scc1 K2_dv_B2_0
K2_dv_R2_0:
    v_lshlrev_b32 v38, 16, v116
    v_and_b32 v39, v3, v116
    v_mul_f32 v73, v38, v73
    v_mul_f32 v77, v39, v77
    v_lshlrev_b32 v40, 16, v117
    v_fmac_f32 v42, v40, v65
    v_fmac_f32 v43, v117, v69
    v_lshlrev_b32 v38, 16, v118
    v_fmac_f32 v44, v38, v65
    v_fmac_f32 v45, v118, v69
    v_lshlrev_b32 v40, 16, v119
    v_fmac_f32 v46, v40, v65
    v_fmac_f32 v47, v119, v69
    s_sub_u32 s54, s54, 1
    s_cbranch_scc1 K2_dv_B2_1
K2_dv_R2_1:
    v_lshlrev_b32 v38, 16, v120
    v_and_b32 v39, v3, v120
    v_mul_f32 v74, v38, v74
    v_mul_f32 v78, v39, v78
    v_lshlrev_b32 v40, 16, v121
    v_fmac_f32 v42, v40, v66
    v_fmac_f32 v43, v121, v70
    v_lshlrev_b32 v38, 16, v122
    v_fmac_f32 v44, v38, v66
    v_fmac_f32 v45, v122, v70
    v_lshlrev_b32 v40, 16, v123
    v_fmac_f32 v46, v40, v66
    v_fmac_f32 v47, v123, v70
    s_sub_u32 s54, s54, 1
    s_cbranch_scc1 K2_dv_B2_2
K2_dv_R2_2:
    v_lshlrev_b32 v38, 16, v124
    v_and_b32 v39, v3, v124
    v_mul_f32 v75, v38, v75
    v_mul_f32 v79, v39, v79
    v_lshlrev_b32 v40, 16, v125
    v_fmac_f32 v42, v40, v67
    v_fmac_f32 v43, v125, v71
    v_lshlrev_b32 v38, 16, v126
    v_fmac_f32 v44, v38, v67
    v_fmac_f32 v45, v126, v71
    v_lshlrev_b32 v40, 16, v127
    v_fmac_f32 v46, v40, v67
    v_fmac_f32 v47, v127, v71
    s_sub_u32 s54, s54, 1
    s_cbranch_scc1 K2_dv_B2_3
    v_cvt_pk_bf16_f32 v52, v72, v73
    v_cvt_pk_bf16_f32 v53, v74, v75
    v_cvt_pk_bf16_f32 v54, v76, v77
    v_cvt_pk_bf16_f32 v55, v78, v79
    s_waitcnt lgkmcnt(0)
    s_nop 0
    v_mfma_f32_16x16x16_bf16 v[56:59], v[32:33], v[52:53], v[56:59]
    v_mfma_f32_16x16x16_bf16 v[60:63], v[32:33], v[54:55], v[60:63]
    s_branch K2_dv_IT0
K2_dv_W0:
    s_waitcnt vmcnt(8)
    s_branch K2_dv_C0
K2_dv_NI0:
    s_cmp_eq_i32 s55, -4
    s_cbranch_scc1 K2_dv_NZ0
    v_xor_b32 v48, v20, v48
    buffer_load_dwordx4 v[112:115], v48, s[16:19], 0 offen
    s_cmp_eq_i32 s55, -3
    s_cbranch_scc1 K2_dv_NP0
    v_xor_b32 v49, v20, v49
    buffer_load_dwordx4 v[116:119], v49, s[16:19], 0 offen
    s_cmp_eq_i32 s55, -2
    s_cbranch_scc1 K2_dv_NP0
    v_xor_b32 v50, v20, v50
    buffer_load_dwordx4 v[120:123], v50, s[16:19], 0 offen
K2_dv_NP0:
    s_mov_b32 s55, 0
    s_waitcnt vmcnt(5)
    s_branch K2_dv_C0
K2_dv_NZ0:
    s_mov_b32 s55, 0
    s_waitcnt vmcnt(0)
    s_nop 1
    s_branch K2_dv_C0
K2_dv_B0_0:
    s_call_b64 s[42:43], K2_dv_Q0
    s_cbranch_scc1 K2_dv_DONE
    s_branch K2_dv_R0_0
K2_dv_B0_1:
    s_call_b64 s[42:43], K2_dv_Q1
    s_cbranch_scc1 K2_dv_DONE
    s_branch K2_dv_R0_1
K2_dv_B0_2:
    s_call_b64 s[42:43], K2_dv_Q2
    s_cbranch_scc1 K2_dv_DONE
    s_branch K2_dv_R0_2
K2_dv_B0_3:
    s_call_b64 s[42:43], K2_dv_Q3
    s_cbranch_scc1 K2_dv_DONE
    s_branch K2_dv_IT1
K2_dv_W1:
    s_waitcnt vmcnt(8)
    s_branch K2_dv_C1
K2_dv_NI1:
    s_cmp_eq_i32 s55, -4
    s_cbranch_scc1 K2_dv_NZ1
    v_xor_b32 v48, v20, v48
    buffer_load_dwordx4 v[80:83], v48, s[16:19], 0 offen
    s_cmp_eq_i32 s55, -3
    s_cbranch_scc1 K2_dv_NP1
    v_xor_b32 v49, v20, v49
    buffer_load_dwordx4 v[84:87], v49, s[16:19], 0 offen
    s_cmp_eq_i32 s55, -2
    s_cbranch_scc1 K2_dv_NP1
    v_xor_b32 v50, v20, v50
    buffer_load_dwordx4 v[88:91], v50, s[16:19], 0 offen
K2_dv_NP1:
    s_mov_b32 s55, 0
    s_waitcnt vmcnt(5)
    s_branch K2_dv_C1
K2_dv_NZ1:
    s_mov_b32 s55, 0
    s_waitcnt vmcnt(0)
    s_nop 1
    s_branch K2_dv_C1
K2_dv_B1_0:
    s_call_b64 s[42:43], K2_dv_Q0
    s_cbranch_scc1 K2_dv_DONE
    s_branch K2_dv_R1_0
K2_dv_B1_1:
    s_call_b64 s[42:43], K2_dv_Q1
    s_cbranch_scc1 K2_dv_DONE
    s_branch K2_dv_R1_1
K2_dv_B1_2:
    s_call_b64 s[42:43], K2_dv_Q2
    s_cbranch_scc1 K2_dv_DONE
    s_branch K2_dv_R1_2
K2_dv_B1_3:
    s_call_b64 s[42:43], K2_dv_Q3
    s_cbranch_scc1 K2_dv_DONE
    s_branch K2_dv_IT2
K2_dv_W2:
    s_waitcnt vmcnt(8)
    s_branch K2_dv_C2
K2_dv_NI2:
    s_cmp_eq_i32 s55, -4
    s_cbranch_scc1 K2_dv_NZ2
    v_xor_b32 v48, v20, v48
    buffer_load_dwordx4 v[96:99], v48, s[16:19], 0 offen
    s_cmp_eq_i32 s55, -3
    s_cbranch_scc1 K2_dv_NP2
    v_xor_b32 v49, v20, v49
    buffer_load_dwordx4 v[100:103], v49, s[16:19], 0 offen
    s_cmp_eq_i32 s55, -2
    s_cbranch_scc1 K2_dv_NP2
    v_xor_b32 v50, v20, v50
    buffer_load_dwordx4 v[104:107], v50, s[16:19], 0 offen
K2_dv_NP2:
    s_mov_b32 s55, 0
    s_waitcnt vmcnt(5)
    s_branch K2_dv_C2
K2_dv_NZ2:
    s_mov_b32 s55, 0
    s_waitcnt vmcnt(0)
    s_nop 1
    s_branch K2_dv_C2
K2_dv_B2_0:
    s_call_b64 s[42:43], K2_dv_Q0
    s_cbranch_scc1 K2_dv_DONE
    s_branch K2_dv_R2_0
K2_dv_B2_1:
    s_call_b64 s[42:43], K2_dv_Q1
    s_cbranch_scc1 K2_dv_DONE
    s_branch K2_dv_R2_1
K2_dv_B2_2:
    s_call_b64 s[42:43], K2_dv_Q2
    s_cbranch_scc1 K2_dv_DONE
    s_branch K2_dv_R2_2
K2_dv_B2_3:
    s_call_b64 s[42:43], K2_dv_Q3
    s_cbranch_scc1 K2_dv_DONE
    s_branch K2_dv_IT0
K2_dv_Q0:
    v_cvt_pk_bf16_f32 v52, v72, 0
    v_mov_b32 v53, 0
    v_cvt_pk_bf16_f32 v54, v76, 0
    v_mov_b32 v55, 0
    v_mov_b32 v72, 0
    v_mov_b32 v76, 0
    s_branch K2_dv_QC
K2_dv_Q1:
    v_cvt_pk_bf16_f32 v52, v72, v73
    v_mov_b32 v53, 0
    v_cvt_pk_bf16_f32 v54, v76, v77
    v_mov_b32 v55, 0
    v_mov_b32 v72, 0
    v_mov_b32 v73, 0
    v_mov_b32 v76, 0
    v_mov_b32 v77, 0
    s_branch K2_dv_QC
K2_dv_Q2:
    v_cvt_pk_bf16_f32 v52, v72, v73
    v_cvt_pk_bf16_f32 v53, v74, 0
    v_cvt_pk_bf16_f32 v54, v76, v77
    v_cvt_pk_bf16_f32 v55, v78, 0
    v_mov_b32 v72, 0
    v_mov_b32 v73, 0
    v_mov_b32 v74, 0
    v_mov_b32 v76, 0
    v_mov_b32 v77, 0
    v_mov_b32 v78, 0
    s_branch K2_dv_QC
K2_dv_Q3:
    v_cvt_pk_bf16_f32 v52, v72, v73
    v_cvt_pk_bf16_f32 v53, v74, v75
    v_cvt_pk_bf16_f32 v54, v76, v77
    v_cvt_pk_bf16_f32 v55, v78, v79
K2_dv_QC:
    s_waitcnt lgkmcnt(0)
    s_nop 0
    v_mfma_f32_16x16x16_bf16 v[56:59], v[32:33], v[52:53], v[56:59]
    v_mfma_f32_16x16x16_bf16 v[60:63], v[32:33], v[54:55], v[60:63]
    s_add_u32 s56, s56, 1
    s_lshr_b64 s[52:53], s[52:53], 8
    s_and_b32 s54, s52, 255
    s_sub_u32 s54, s54, 1
    s_bitset1_b32 s57, 1
    s_cmp_lg_u32 s51, 0
    s_cbranch_scc1 K2_dv_SLOW
K2_dv_FIN:
    v_lshlrev_b32 v38, 16, v35
    v_and_b32 v39, v3, v35
    v_add_f32 v42, v42, v56
    v_add_f32 v43, v43, v60
    v_add_f32 v38, v38, v42
    v_add_f32 v39, v39, v43
    v_cvt_pk_bf16_f32 v52, v38, v39
    buffer_store_dword v52, v27, s[32:35], 0 offen offset:0 sc1
    v_lshlrev_b32 v40, 16, v36
    v_and_b32 v41, v3, v36
    v_add_f32 v44, v44, v57
    v_add_f32 v45, v45, v61
    v_add_f32 v40, v40, v44
    v_add_f32 v41, v41, v45
    v_cvt_pk_bf16_f32 v53, v40, v41
    buffer_store_dword v53, v27, s[32:35], 0 offen offset:512 sc1
    v_lshlrev_b32 v38, 16, v37
    v_and_b32 v39, v3, v37
    v_add_f32 v46, v46, v58
    v_add_f32 v47, v47, v62
    v_add_f32 v38, v38, v46
    v_add_f32 v39, v39, v47
    v_cvt_pk_bf16_f32 v54, v38, v39
    buffer_store_dword v54, v27, s[32:35], 0 offen offset:1024 sc1
K2_dv_NXT:
    s_cmp_ge_u32 s56, s58
    s_cbranch_scc1 K2_dv_RET
    v_lshl_add_u32 v27, v28, 17, v26
    v_lshl_add_u32 v28, v28, 9, v12
    ds_read_b32 v35, v28 offset:0
    ds_read_b32 v36, v28 offset:128
    ds_read_b32 v37, v28 offset:256
    v_add_u32 v29, 16, v29
    ds_read_b32 v28, v29 offset:1280
    v_mov_b32 v42, 0
    v_mov_b32 v43, 0
    v_mov_b32 v44, 0
    v_mov_b32 v45, 0
    v_mov_b32 v46, 0
    v_mov_b32 v47, 0
    v_mov_b32 v56, 0
    v_mov_b32 v57, 0
    v_mov_b32 v58, 0
    v_mov_b32 v60, 0
    v_mov_b32 v61, 0
    v_mov_b32 v62, 0
    s_cmp_eq_u32 s72, 0
    s_cbranch_scc1 K2_dv_P
    s_setprio 0
    s_cmp_lt_u32 s3, 4
    s_cbranch_scc1 K2_PR_6
    s_setprio 0
    s_cmp_lt_u32 s3, 8
    s_cbranch_scc1 K2_PR_6
    s_setprio 1
    s_cmp_lt_u32 s3, 12
    s_cbranch_scc1 K2_PR_6
    s_setprio 2
K2_PR_6:
K2_dv_P:
    s_cmp_ge_u32 s56, s58
K2_dv_RET:
    s_setpc_b64 s[42:43]
K2_dv_SLOW:
    v_sub_u32 v38, v27, v26
    v_lshrrev_b32 v38, 7, v38
    v_lshl_add_u32 v38, v1, 3, v38
    v_add_f32 v42, v42, v56
    v_add_f32 v43, v43, v60
    v_add_f32 v44, v44, v57
    v_add_f32 v45, v45, v61
    v_add_f32 v46, v46, v58
    v_add_f32 v47, v47, v62
    s_bitcmp0_b32 s51, 0
    s_cbranch_scc1 K2_dv_SL1
    buffer_load_dwordx2 v[56:57], v38, s[24:27], s73 offen offset:0
    buffer_load_dwordx2 v[58:59], v38, s[24:27], s73 offen offset:128
    buffer_load_dwordx2 v[60:61], v38, s[24:27], s73 offen offset:256
    s_waitcnt vmcnt(0)
    v_add_f32 v42, v42, v56
    v_add_f32 v43, v43, v57
    v_add_f32 v44, v44, v58
    v_add_f32 v45, v45, v59
    v_add_f32 v46, v46, v60
    v_add_f32 v47, v47, v61
K2_dv_SL1:
    s_bitcmp1_b32 s51, 1
    s_cbranch_scc1 K2_dv_SL2
    v_mov_b32 v56, 0
    v_mov_b32 v57, 0
    v_mov_b32 v58, 0
    v_mov_b32 v59, 0
    v_mov_b32 v60, 0
    v_mov_b32 v61, 0
    v_mov_b32 v62, 0
    v_mov_b32 v63, 0
    s_bitcmp0_b32 s51, 2
    s_cbranch_scc1 K2_dv_FIN
    buffer_load_dword v35, v27, s[28:31], 0 offen offset:0
    buffer_load_dword v36, v27, s[28:31], 0 offen offset:512
    buffer_load_dword v37, v27, s[28:31], 0 offen offset:1024
    s_waitcnt vmcnt(0)
    s_branch K2_dv_FIN
K2_dv_SL2:
    buffer_store_dwordx2 v[42:43], v38, s[24:27], s73 offen offset:0
    buffer_store_dwordx2 v[44:45], v38, s[24:27], s73 offen offset:128
    buffer_store_dwordx2 v[46:47], v38, s[24:27], s73 offen offset:256
    s_waitcnt vmcnt(0)
    s_branch K2_dv_NXT
K2_dv_DONE:
    s_cmp_lg_u32 s72, 0
    s_cbranch_scc1 K2_dv_FINI
    s_mov_b32 s72, 1
    s_setprio 1
    s_branch K2_dv_PH
K2_dv_FINI:
    s_bitcmp0_b32 s51, 1
    s_cbranch_scc1 K2_END
    s_setprio 0
    s_waitcnt vmcnt(0)
    s_barrier
    s_branch K2_ROUND
K2_END:
    s_endpgm
.section .rodata,"a"
.p2align 6
.amdhsa_kernel standalone__molecular_angular_painn__graph_kernel
  .amdhsa_next_free_vgpr 128
  .amdhsa_next_free_sgpr 84
  .amdhsa_accum_offset 128
  .amdhsa_group_segment_fixed_size 0
  .amdhsa_kernarg_size 88
  .amdhsa_user_sgpr_count 2
  .amdhsa_user_sgpr_kernarg_segment_ptr 1
  .amdhsa_system_sgpr_workgroup_id_x 1
  .amdhsa_float_denorm_mode_32 3
.end_amdhsa_kernel
```
